```python
import torch

def _softmax(x, axis=-1):
    return torch.softmax(x, dim=axis)
def _gelu(x):
    return torch.nn.functional.gelu(x, approximate="tanh")
def _silu(x):
    return torch.nn.functional.silu(x)
def _sigmoid(x):
    return torch.sigmoid(x)
def _layernorm(x, axis=-1, eps=1e-5):
    m = x.mean(dim=axis, keepdim=True)
    v = x.var(dim=axis, keepdim=True, unbiased=False)
    return (x - m) / torch.sqrt(v + eps)
def _scatter_add(tgt, idx, src, axis=0):
    return tgt.clone().index_add_(axis, idx, src)
def _segment_sum(src, seg, n):
    out = torch.zeros((n,) + src.shape[1:], dtype=src.dtype)
    return out.index_add_(0, seg, src)
def _pad(x, pw):
    flat = tuple(v for pair in reversed(pw) for v in pair)
    return torch.nn.functional.pad(x, flat)

kernel_name = 'recurrent_scan__grouped_kv_mqa__moe_arch_mod__prompt'

def setup_inputs():

    _w = (lambda a: (lambda t: t.to(torch.bfloat16) if t.is_floating_point() else t)(torch.as_tensor(a)))
    def _A_setup():
        B, S, D, H = 1, 2048, 512, 32
        Dh = D // H
        return {
            "x": _w((lambda *s: torch.randn(*s, dtype=torch.bfloat16) * 0.05)(B, S, D)),
            "wq": _w((lambda *s: torch.randn(*s, dtype=torch.bfloat16) * 0.05)(D, H * Dh)),
            "wk": _w((lambda *s: torch.randn(*s, dtype=torch.bfloat16) * 0.05)(D, Dh)),
            "wv": _w((lambda *s: torch.randn(*s, dtype=torch.bfloat16) * 0.05)(D, Dh)),
            "wo": _w((lambda *s: torch.randn(*s, dtype=torch.bfloat16) * 0.05)(H * Dh, D)),
        }
    _A_in = _A_setup()

    def _B_setup():
        B, S, D, F, C = 1, 2048, 512, 1792, 2
        return {
            "x": _w((lambda *s: torch.randn(*s, dtype=torch.bfloat16) * 0.05)(B, S, D)),
            "w_r": _w((lambda *s: torch.randn(*s, dtype=torch.bfloat16) * 1.6)(D)),
            "w_gate": _w((lambda *s: torch.randn(*s, dtype=torch.bfloat16) * 0.1)(D, F)),
            "w_up": _w((lambda *s: torch.randn(*s, dtype=torch.bfloat16) * 0.1)(D, F)),
            "w_down": _w((lambda *s: torch.randn(*s, dtype=torch.bfloat16) * 0.1)(F, D)),
        }
    _B_in = _B_setup()

    return {
        "A_x": _A_in["x"],
        "A_wq": _A_in["wq"],
        "A_wk": _A_in["wk"],
        "A_wv": _A_in["wv"],
        "A_wo": _A_in["wo"],
        "B_x": _B_in["x"],
        "B_w_r": _B_in["w_r"],
        "B_w_gate": _B_in["w_gate"],
        "B_w_up": _B_in["w_up"],
        "B_w_down": _B_in["w_down"],
    }

def reference(A_x, A_wq, A_wk, A_wv, A_wo, B_x, B_w_r, B_w_gate, B_w_up, B_w_down):
    def _A_ref(x, wq, wk, wv, wo):
        B, S, D = x.shape
        H = 32
        Dh = D // H
        q = (lambda x, *d: x.permute(*d))((x @ wq).reshape(B, S, H, Dh), 0, 2, 1, 3)
        k = x @ wk
        v = x @ wv
        scores = torch.einsum("bhqd,bkd->bhqk", q, k) * (Dh ** -0.5)
        p = _softmax(scores, axis=-1)
        o = torch.einsum("bhqk,bkd->bhqd", p, v)
        return (lambda x, *d: x.permute(*d))(o, 0, 2, 1, 3).reshape(B, S, H * Dh) @ wo

    def _B_ref(x, w_r, w_gate, w_up, w_down):
        B, S, D = x.shape
        C = 2
        r = x @ w_r
        idx = torch.argsort(-r, axis=-1)[:, :C]
        idx_e = (lambda x, n, axis: torch.repeat_interleave(x, n, dim=axis))(idx.reshape(B, C, 1), D, axis=2)
        x_sel = (lambda x, i, axis: torch.take_along_dim(x, i, dim=axis))(x, idx_e, axis=1)
        g = _silu(x_sel @ w_gate)
        u = x_sel @ w_up
        y = (g * u) @ w_down
        r_sel = _sigmoid((lambda x, i, axis: torch.take_along_dim(x, i, dim=axis))(r, idx, axis=1))
        y = y * r_sel.reshape(B, C, 1)
        b_off = (torch.arange(B) * S).reshape(B, 1)
        flat_idx = (idx + b_off).reshape(B * C)
        zero = (x * 0.0).reshape(B * S, D)
        upd = _scatter_add(zero, flat_idx, y.reshape(B * C, D), axis=0)
        return x + upd.reshape(B, S, D)

    x = A_x
    xn = _layernorm(x, axis=-1)
    s = _A_ref(xn, A_wq, A_wk, A_wv, A_wo)
    g = _silu(_B_ref(xn, B_w_r, B_w_gate, B_w_up, B_w_down))
    return x + s * g
```

```asm
; @launch grid=(256,1,1) block=(768,1,1) lds=163840
.amdgcn_target "amdgcn-amd-amdhsa--gfx950"
.text
.globl recurrent_scan__grouped_kv_mqa__moe_arch_mod__prompt_kernel
.p2align 8
.type recurrent_scan__grouped_kv_mqa__moe_arch_mod__prompt_kernel,@function
recurrent_scan__grouped_kv_mqa__moe_arch_mod__prompt_kernel:
    s_cmp_ge_u32 s2, 256
    s_cbranch_scc1 L_END
    s_load_dwordx8 s[4:11], s[0:1], 0
    s_load_dwordx2 s[12:13], s[0:1], 32
    s_load_dwordx2 s[14:15], s[0:1], 96
    s_load_dwordx2 s[28:29], s[0:1], 48
    s_load_dwordx2 s[72:73], s[0:1], 88
    v_and_b32 v1, 63, v0
    v_lshrrev_b32 v2, 6, v0
    s_nop 0
    v_readfirstlane_b32 s78, v2
    s_and_b32 s17, s2, 7
    s_lshr_b32 s18, s2, 3
    s_and_b32 s19, s18, 3
    s_lshl_b32 s17, s17, 2
    s_add_u32 s17, s17, s19
    s_lshl_b32 s17, s17, 6
    s_lshr_b32 s19, s18, 2
    s_lshl_b32 s18, s19, 6
    s_and_b32 s16, s78, 3
    s_mov_b32 s42, 0xffff0000
    v_lshlrev_b32 v5, 4, v1
    s_waitcnt lgkmcnt(0)
    s_mov_b32 s20, s4
    s_mov_b32 s21, s5
    s_mov_b32 s22, 0x200000
    s_mov_b32 s23, 0x00020000
    s_mov_b32 s24, s14
    s_mov_b32 s25, s15
    s_mov_b32 s26, 0xa0000
    s_mov_b32 s27, 0x00020000
    s_mov_b32 s74, 256
    s_mov_b32 s75, 0x00020000
    s_cmp_ge_u32 s78, 8
    s_cbranch_scc1 R_GEMM
    s_cmp_ge_u32 s78, 4
    s_cbranch_scc1 R_LN
R_AUX:
    s_cmp_ge_u32 s16, 2
    s_cbranch_scc1 R_AUX2
    s_mov_b32 s52, s28
    s_mov_b32 s53, s29
    s_mov_b32 s54, 0x400
    s_mov_b32 s55, 0x00020000
    s_mov_b32 s28, s6
    s_mov_b32 s29, s7
    s_mov_b32 s30, 0x80000
    s_mov_b32 s31, 0x00020000
    v_lshrrev_b32 v2, 3, v1
    v_lshlrev_b32 v2, 10, v2
    v_lshrrev_b32 v3, 4, v1
    v_xor_b32 v6, v3, v1
    v_and_b32 v6, 7, v6
    v_lshl_add_u32 v8, v6, 4, v2
    v_xor_b32 v9, 64, v8
    v_and_b32 v6, 1, v3
    v_lshlrev_b32 v6, 2, v6
    v_xor_b32 v6, v6, v1
    v_and_b32 v6, 7, v6
    v_lshl_add_u32 v4, v6, 4, v2
    s_lshl_b32 s43, s16, 15
    s_lshl_b32 s44, s17, 10
    s_add_u32 s44, s44, s43
    s_lshl_b32 s45, s18, 1
    s_add_u32 s45, s45, s43
    s_lshl_b32 s46, s16, 12
    s_lshl_b32 s47, s19, 3
    s_add_u32 s47, s47, s17
    s_lshl_b32 s48, s16, 2
    s_add_u32 s47, s47, s48
    s_lshl_b32 s47, s47, 10
    s_mul_i32 s48, s16, 4160
    s_add_u32 m0, s48, 147456
    s_add_u32 s40, s47, 0
    buffer_load_dwordx4 v5, s[20:23], s40 offen lds
    s_add_u32 m0, s48, 148496
    s_add_u32 s40, s47, 1024
    buffer_load_dwordx4 v5, s[20:23], s40 offen lds
    s_add_u32 m0, s48, 149536
    s_add_u32 s40, s47, 2048
    buffer_load_dwordx4 v5, s[20:23], s40 offen lds
    s_add_u32 m0, s48, 150576
    s_add_u32 s40, s47, 3072
    buffer_load_dwordx4 v5, s[20:23], s40 offen lds
    s_mov_b32 m0, 155776
    s_lshl_b32 s47, s16, 13
    buffer_load_dwordx4 v5, s[52:55], 0 offen lds
    s_mov_b32 s32, s8
    s_mov_b32 s33, s9
    s_mov_b32 s34, 0x4000
    s_mov_b32 s35, 0x00020000
    s_mov_b32 s36, s10
    s_mov_b32 s37, s11
    s_mov_b32 s38, 0x4000
    s_mov_b32 s39, 0x00020000
    s_lshl_b32 s40, s16, 2
    s_add_u32 s40, s40, 156928
    v_mov_b32 v10, s40
    v_mov_b32 v11, 1
    s_add_u32 m0, s47, 114688
    s_add_u32 s40, s47, 0
    buffer_load_dwordx4 v5, s[32:35], s40 offen lds
    s_add_u32 m0, s47, 115712
    s_add_u32 s40, s47, 1024
    buffer_load_dwordx4 v5, s[32:35], s40 offen lds
    s_add_u32 m0, s47, 116736
    s_add_u32 s40, s47, 2048
    buffer_load_dwordx4 v5, s[32:35], s40 offen lds
    s_add_u32 m0, s47, 117760
    s_add_u32 s40, s47, 3072
    buffer_load_dwordx4 v5, s[32:35], s40 offen lds
    s_add_u32 m0, s47, 118784
    s_add_u32 s40, s47, 4096
    buffer_load_dwordx4 v5, s[32:35], s40 offen lds
    s_add_u32 m0, s47, 119808
    s_add_u32 s40, s47, 5120
    buffer_load_dwordx4 v5, s[32:35], s40 offen lds
    s_add_u32 m0, s47, 120832
    s_add_u32 s40, s47, 6144
    buffer_load_dwordx4 v5, s[32:35], s40 offen lds
    s_add_u32 m0, s47, 121856
    s_add_u32 s40, s47, 7168
    buffer_load_dwordx4 v5, s[32:35], s40 offen lds
    s_barrier
    s_waitcnt vmcnt(8)
    s_mov_b64 exec, 1
    ds_add_u32 v10, v11 offset:0
    s_mov_b64 exec, -1
    s_add_u32 m0, s47, 131072
    s_add_u32 s40, s47, 0
    buffer_load_dwordx4 v5, s[36:39], s40 offen lds
    s_add_u32 m0, s47, 132096
    s_add_u32 s40, s47, 1024
    buffer_load_dwordx4 v5, s[36:39], s40 offen lds
    s_add_u32 m0, s47, 133120
    s_add_u32 s40, s47, 2048
    buffer_load_dwordx4 v5, s[36:39], s40 offen lds
    s_add_u32 m0, s47, 134144
    s_add_u32 s40, s47, 3072
    buffer_load_dwordx4 v5, s[36:39], s40 offen lds
    s_add_u32 m0, s47, 135168
    s_add_u32 s40, s47, 4096
    buffer_load_dwordx4 v5, s[36:39], s40 offen lds
    s_add_u32 m0, s47, 136192
    s_add_u32 s40, s47, 5120
    buffer_load_dwordx4 v5, s[36:39], s40 offen lds
    s_add_u32 m0, s47, 137216
    s_add_u32 s40, s47, 6144
    buffer_load_dwordx4 v5, s[36:39], s40 offen lds
    s_add_u32 m0, s47, 138240
    s_add_u32 s40, s47, 7168
    buffer_load_dwordx4 v5, s[36:39], s40 offen lds
    s_mov_b32 s47, s46
    s_mov_b32 s51, s19
    s_mov_b32 s50, 0
LD_P1:
    s_cmp_lg_u32 s50, 7
    s_cbranch_scc1 LD_NOWRAP
    s_mov_b32 s47, s46
    v_mov_b32 v16, 0x26500
LW_L:
    ds_read_b32 v14, v16 offset:8
    s_waitcnt lgkmcnt(0)
    v_readfirstlane_b32 s62, v14
    s_cmp_lt_u32 s62, 4
    s_cbranch_scc1 LW_L
LD_NOWRAP:
    s_lshl_b32 s48, s51, 16
    s_add_u32 s48, s48, s45
    s_lshl_b32 s49, s51, 7
    s_add_u32 s49, s49, s44
    s_add_u32 s51, s51, 1
    s_and_b32 s51, s51, 7
    s_add_u32 m0, s47, 57344
    s_add_u32 s40, s48, 0
    buffer_load_dwordx4 v4, s[28:31], s40 offen lds
    s_add_u32 m0, s47, 58368
    s_add_u32 s40, s48, 8192
    buffer_load_dwordx4 v4, s[28:31], s40 offen lds
    s_add_u32 m0, s47, 59392
    s_add_u32 s40, s48, 16384
    buffer_load_dwordx4 v4, s[28:31], s40 offen lds
    s_add_u32 m0, s47, 60416
    s_add_u32 s40, s48, 24576
    buffer_load_dwordx4 v4, s[28:31], s40 offen lds
    s_add_u32 m0, s47, 0
    s_add_u32 s40, s49, 0
    buffer_load_dwordx4 v8, s[20:23], s40 offen lds
    s_add_u32 m0, s47, 1024
    s_add_u32 s40, s49, 8192
    buffer_load_dwordx4 v9, s[20:23], s40 offen lds
    s_add_u32 m0, s47, 2048
    s_add_u32 s40, s49, 16384
    buffer_load_dwordx4 v8, s[20:23], s40 offen lds
    s_add_u32 m0, s47, 3072
    s_add_u32 s40, s49, 24576
    buffer_load_dwordx4 v9, s[20:23], s40 offen lds
    s_add_u32 s47, s47, 8192
    s_add_u32 s50, s50, 1
    s_cmp_lt_u32 s50, 2
    s_cbranch_scc1 LD_P1
    s_waitcnt vmcnt(16)
    s_mov_b64 exec, 1
    ds_add_u32 v10, v11 offset:0
    s_mov_b64 exec, -1
    s_cmp_lt_u32 s50, 8
    s_cbranch_scc1 LD_P1
    s_waitcnt vmcnt(8)
    s_mov_b64 exec, 1
    ds_add_u32 v10, v11 offset:0
    s_mov_b64 exec, -1
    s_waitcnt vmcnt(0)
    s_mov_b64 exec, 1
    ds_add_u32 v10, v11 offset:0
    s_mov_b64 exec, -1
    s_barrier
    s_barrier
    s_mov_b32 s28, s12
    s_mov_b32 s29, s13
    s_mov_b32 s30, 0x80000
    s_mov_b32 s31, 0x00020000
    s_add_u32 s47, s46, 65536
    s_mov_b32 s48, s45
    s_mov_b32 s49, 0
LD_WO:
    s_add_u32 m0, s47, 0
    s_add_u32 s40, s48, 0
    buffer_load_dwordx4 v4, s[28:31], s40 offen lds
    s_add_u32 m0, s47, 1024
    s_add_u32 s40, s48, 8192
    buffer_load_dwordx4 v4, s[28:31], s40 offen lds
    s_waitcnt vmcnt(0)
    s_add_u32 m0, s47, 2048
    s_add_u32 s40, s48, 16384
    buffer_load_dwordx4 v4, s[28:31], s40 offen lds
    s_add_u32 m0, s47, 3072
    s_add_u32 s40, s48, 24576
    buffer_load_dwordx4 v4, s[28:31], s40 offen lds
    s_waitcnt vmcnt(0)
    s_add_u32 s47, s47, 8192
    s_add_u32 s48, s48, 65536
    s_add_u32 s49, s49, 1
    s_cmp_lt_u32 s49, 8
    s_cbranch_scc1 LD_WO
    s_add_u32 s32, s14, 0x200000
    s_addc_u32 s33, s15, 0
    s_mov_b32 s34, 0x200000
    s_mov_b32 s35, 0x00020000
    s_barrier
    s_barrier
P3LOAD:
    v_lshrrev_b32 v2, 3, v1
    v_lshrrev_b32 v3, 4, v1
    v_xor_b32 v3, v3, v1
    v_and_b32 v3, 7, v3
    v_lshlrev_b32 v8, 7, v2
    v_lshl_add_u32 v8, v3, 4, v8
    v_xor_b32 v9, 64, v8
    v_mov_b32 v6, 0x23000
    s_lshl_b32 s44, s17, 10
PL_LOOP:
    ds_read2_b32 v[12:13], v6 offset0:5 offset1:7
    s_waitcnt lgkmcnt(0)
    v_readfirstlane_b32 s50, v12
    v_readfirstlane_b32 s51, v13
    s_cmp_eq_u32 s50, 0xff
    s_cbranch_scc1 PL_END
    s_andn2_b32 s51, s51, s50
    s_cbranch_scc0 PL_LOOP
    s_ff1_i32_b32 s52, s51
    s_lshl_b32 s53, 1, s52
    v_mov_b32 v11, s53
    s_mov_b64 exec, 1
    ds_or_rtn_b32 v12, v6, v11 offset:20
    s_waitcnt lgkmcnt(0)
    s_mov_b64 exec, -1
    v_readfirstlane_b32 s50, v12
    s_and_b32 s50, s50, s53
    s_cbranch_scc1 PL_LOOP
    s_lshl_b32 s47, s52, 13
    s_add_u32 s49, s47, s44
    s_add_u32 m0, s47, 0
    s_add_u32 s40, s49, 0
    buffer_load_dwordx4 v8, s[32:35], s40 offen lds
    s_add_u32 m0, s47, 1024
    s_add_u32 s40, s49, 1024
    buffer_load_dwordx4 v9, s[32:35], s40 offen lds
    s_add_u32 m0, s47, 2048
    s_add_u32 s40, s49, 2048
    buffer_load_dwordx4 v8, s[32:35], s40 offen lds
    s_add_u32 m0, s47, 3072
    s_add_u32 s40, s49, 3072
    buffer_load_dwordx4 v9, s[32:35], s40 offen lds
    s_add_u32 m0, s47, 4096
    s_add_u32 s40, s49, 4096
    buffer_load_dwordx4 v8, s[32:35], s40 offen lds
    s_add_u32 m0, s47, 5120
    s_add_u32 s40, s49, 5120
    buffer_load_dwordx4 v9, s[32:35], s40 offen lds
    s_add_u32 m0, s47, 6144
    s_add_u32 s40, s49, 6144
    buffer_load_dwordx4 v8, s[32:35], s40 offen lds
    s_add_u32 m0, s47, 7168
    s_add_u32 s40, s49, 7168
    buffer_load_dwordx4 v9, s[32:35], s40 offen lds
    s_waitcnt vmcnt(0)
    s_mov_b64 exec, 1
    ds_or_b32 v6, v11 offset:16
    s_mov_b64 exec, -1
    s_branch PL_LOOP
PL_END:
    s_waitcnt lgkmcnt(0)
    s_endpgm
R_AUX2:
    s_and_b32 s16, s16, 1
    v_mov_b32 v2, 0
    s_cmp_eq_u32 s16, 0
    s_cbranch_scc1 AUX_NOTAG
    s_cmp_lg_u32 s2, 0
    s_cbranch_scc1 AUX_NOTAG
    s_memrealtime s[48:49]
    s_waitcnt lgkmcnt(0)
    s_or_b32 s48, s48, 1
    v_mov_b32 v3, s48
    s_mov_b64 exec, 1
    buffer_store_dword v3, v2, s[72:75], 0 offen sc1
    s_mov_b64 exec, -1
AUX_NOTAG:
    v_mov_b32 v6, 0x26500
    v_mov_b64 v[8:9], 0
    v_mov_b64 v[10:11], 0
    ds_write_b128 v6, v[8:11]
    ds_write_b128 v6, v[8:11] offset:16
    s_waitcnt lgkmcnt(0)
    s_barrier
    s_cmp_eq_u32 s16, 0
    s_cbranch_scc1 AUX_FFN0
    s_mov_b32 s61, 0
    v_mov_b32 v2, 0
TAG_AUX:
    buffer_load_dword v3, v2, s[72:75], 0 offen sc1
    s_add_u32 s61, s61, 1
    s_waitcnt vmcnt(0)
    v_readfirstlane_b32 s60, v3
    s_cmp_ge_u32 s61, 131072
    s_cbranch_scc1 TAGX_AUX
    s_cmp_eq_u32 s60, 0
    s_cbranch_scc1 TAG_AUX
TAGX_AUX:
    s_or_b32 s60, s60, 1
    v_mov_b32 v3, s60
    ds_write_b32 v6, v3 offset:20
    v_mov_b32 v3, s60
    s_lshl_b32 s40, s2, 7
    s_add_u32 s40, s40, 262144
    v_and_b32 v7, 31, v1
    v_lshlrev_b32 v7, 10, v7
    v_and_b32 v8, 7, v1
    v_lshlrev_b32 v8, 7, v8
    s_mov_b32 s44, 237568
    s_lshl_b32 s45, s2, 7
    s_add_u32 s45, s45, s44
    s_getreg_b32 s59, hwreg(HW_REG_XCC_ID)
    v_mov_b32 v11, 0xf800
    v_mov_b32 v86, 0x26500
LW_SY:
    ds_read_b32 v84, v86 offset:16
    s_waitcnt lgkmcnt(0)
    v_readfirstlane_b32 s62, v84
    s_cmp_lt_u32 s62, 4
    s_cbranch_scc1 LW_SY
    s_cmp_ge_u32 s2, 8
    s_cbranch_scc1 SYNC_NC
    s_mov_b32 s61, 0
POLL_S0:
    buffer_load_dword v20, v7, s[24:27], s40 offen sc1
    s_add_u32 s61, s61, 1
    s_waitcnt vmcnt(0)
    v_cmp_ne_u32 vcc, s60, v20
    s_cmp_ge_u32 s61, 131072
    s_cbranch_scc1 POLLX_S0
    s_cmp_eq_u64 vcc, 0
    s_cbranch_scc1 POLLX_S0
    s_sleep 1
    s_branch POLL_S0
POLLX_S0:
    s_mov_b64 exec, 1
    buffer_store_dword v3, v2, s[24:27], s45 offen sc1
    s_mov_b64 exec, -1
SYNC_NC:
    s_mov_b32 s61, 0
POLL_S1:
    buffer_load_dword v20, v8, s[24:27], s44 offen sc1
    s_add_u32 s61, s61, 1
    s_waitcnt vmcnt(0)
    v_cmp_ne_u32 vcc, s60, v20
    s_cmp_ge_u32 s61, 131072
    s_cbranch_scc1 POLLX_S1
    s_cmp_eq_u64 vcc, 0
    s_cbranch_scc1 POLLX_S1
    s_sleep 2
    s_branch POLL_S1
POLLX_S1:
    s_cmp_lg_u32 s2, 0
    s_cbranch_scc1 SYNC_NORST
    s_mov_b64 exec, 1
    buffer_store_dword v2, v2, s[72:75], 0 offen sc1
    s_mov_b64 exec, -1
SYNC_NORST:
    s_barrier
    ds_write_b32 v11, v2
    s_waitcnt lgkmcnt(0)
    s_barrier
    s_setprio 3
    s_cmp_lt_u32 s2, 144
    s_cbranch_scc1 SYNC_NB0
    s_load_dwordx2 s[8:9], s[0:1], 72
    s_sub_u32 s56, s2, 144
    s_lshl_b32 s52, s56, 14
    s_mov_b32 s53, 147456
    s_mov_b32 s41, 0
    s_waitcnt lgkmcnt(0)
    s_mov_b32 s36, s8
    s_mov_b32 s37, s9
    s_mov_b32 s38, 0x1c0000
    s_mov_b32 s39, 0x00020000
FFN_DMA2:
    s_mov_b32 m0, s53
    s_add_u32 s53, s53, 1024
    buffer_load_dwordx4 v5, s[36:39], s52 offen lds
    s_add_u32 s52, s52, 1024
    s_add_u32 s41, s41, 1
    s_waitcnt vmcnt(4)
    s_cmp_lt_u32 s41, 16
    s_cbranch_scc1 FFN_DMA2
SYNC_NB0:
    s_lshl_b32 s40, s17, 4
    s_add_u32 s41, s40, 294912
    s_lshl_b32 s40, s19, 7
    s_add_u32 s40, s40, s41
    v_and_b32 v6, 7, v1
    v_lshlrev_b32 v6, 7, v6
    s_and_b32 s44, s2, 31
    s_lshl_b32 s44, s44, 7
    s_add_u32 s44, s44, 262148
    v_lshlrev_b32 v14, 5, v6
    buffer_load_dword v15, v14, s[24:27], s44 offen sc1
    s_waitcnt vmcnt(0)
    v_cmp_ne_u32 vcc, s59, v15
    s_cmp_eq_u64 vcc, 0
    s_cselect_b32 s59, 1, 0
    s_mov_b32 s44, 233472
    s_mov_b32 s61, 0
POLL_SEL:
    buffer_load_dwordx4 v[20:23], v2, s[24:27], s44 offen sc1
    s_add_u32 s61, s61, 1
    s_waitcnt vmcnt(0)
    v_cmp_ne_u32 vcc, s60, v20
    v_cmp_ne_u32 s[62:63], s60, v23
    s_or_b64 vcc, vcc, s[62:63]
    s_cmp_ge_u32 s61, 131072
    s_cbranch_scc1 POLLX_SEL
    s_cmp_eq_u64 vcc, 0
    s_cbranch_scc1 POLLX_SEL
    s_sleep 32
    s_branch POLL_SEL
POLLX_SEL:
    v_readfirstlane_b32 s56, v21
    v_readfirstlane_b32 s57, v22
    v_mov_b32 v23, s59
    ds_write_b128 v11, v[20:23]
    s_waitcnt lgkmcnt(0)
    s_cmp_lt_u32 s2, 144
    s_cbranch_scc1 SYNC_NB1
    s_sub_u32 s56, s2, 144
    s_lshr_b32 s44, s56, 2
    s_lshl_b32 s44, s44, 10
    s_add_u32 s44, s44, 360448
    s_mov_b32 s61, 0
POLL_FA:
    buffer_load_dword v20, v6, s[24:27], s44 offen sc1
    s_add_u32 s61, s61, 1
    s_waitcnt vmcnt(0)
    v_cmp_ne_u32 vcc, s60, v20
    s_cmp_ge_u32 s61, 131072
    s_cbranch_scc1 POLLX_FA
    s_cmp_eq_u64 vcc, 0
    s_cbranch_scc1 POLLX_FA
    s_sleep 8
    s_branch POLL_FA
POLLX_FA:
    v_lshrrev_b32 v7, 4, v1
    v_mul_u32_u24 v7, 7168, v7
    v_and_b32 v8, 15, v1
    v_lshl_add_u32 v7, v8, 2, v7
    s_lshl_b32 s44, s56, 6
    s_add_u32 s44, s44, 393216
    buffer_load_dword v16, v7, s[24:27], s44 offen sc1
    s_add_u32 s44, s44, 28672
    buffer_load_dword v17, v7, s[24:27], s44 offen sc1
    s_add_u32 s44, s44, 28672
    buffer_load_dword v18, v7, s[24:27], s44 offen sc1
    s_add_u32 s44, s44, 28672
    buffer_load_dword v19, v7, s[24:27], s44 offen sc1
    s_add_u32 s44, s44, 28672
    buffer_load_dword v20, v7, s[24:27], s44 offen sc1
    s_add_u32 s44, s44, 28672
    buffer_load_dword v21, v7, s[24:27], s44 offen sc1
    s_add_u32 s44, s44, 28672
    buffer_load_dword v22, v7, s[24:27], s44 offen sc1
    s_add_u32 s44, s44, 28672
    buffer_load_dword v23, v7, s[24:27], s44 offen sc1
    s_add_u32 s44, s44, 28672
    s_add_u32 s44, s14, 0xa0000
    s_addc_u32 s45, s15, 0
    s_mov_b32 s46, 0x70000
    s_mov_b32 s47, 0x00020000
    v_lshrrev_b32 v14, 5, v1
    v_lshrrev_b32 v8, 2, v1
    v_and_b32 v9, 3, v8
    v_lshl_add_u32 v12, v14, 3, v9
    v_lshlrev_b32 v12, 10, v12
    v_and_b32 v9, 16, v1
    v_lshl_add_u32 v12, v9, 1, v12
    v_and_b32 v9, 3, v1
    v_lshl_add_u32 v12, v9, 3, v12
    v_add_u32 v12, 0x24000, v12
    v_and_b32 v8, 1, v8
    v_lshlrev_b32 v8, 5, v8
    v_lshl_add_u32 v8, v14, 4, v8
    v_add_u32 v8, v8, v11
    v_and_b32 v9, 31, v1
    v_lshl_add_u32 v13, v9, 1, v11
    v_lshlrev_b32 v14, 11, v14
    v_lshl_add_u32 v14, v9, 2, v14
    s_lshl_b32 s52, s56, 12
    s_waitcnt vmcnt(0)
    v_add_f32 v16, v16, v17
    v_add_f32 v18, v18, v19
    v_add_f32 v20, v20, v21
    v_add_f32 v22, v22, v23
    v_add_f32 v16, v16, v18
    v_add_f32 v20, v20, v22
    v_add_f32 v16, v16, v20
    v_cvt_pk_bf16_f32 v16, v16, v16
    v_lshlrev_b32 v16, 16, v16
    v_mov_b32 v17, v16
    s_nop 1
    v_permlane32_swap_b32 v16, v17
    s_nop 1
    v_mul_f32 v18, 0xbfb8aa3b, v16
    v_exp_f32 v18, v18
    s_nop 0
    v_add_f32 v18, 1.0, v18
    v_rcp_f32 v18, v18
    s_nop 0
    v_mul_f32 v16, v16, v18
    v_cvt_pk_bf16_f32 v16, v16, v16
    v_lshlrev_b32 v16, 16, v16
    v_mul_f32 v16, v16, v17
    v_cvt_pk_bf16_f32 v16, v16, v16
    ds_write_b16 v13, v16 offset:64
    s_waitcnt lgkmcnt(0)
    ds_read_b128 v[24:27], v8 offset:64
    s_mov_b32 s53, 0
FFN_DOWN:
    ds_read_b64_tr_b16 v[96:97], v12 offset:0
    ds_read_b64_tr_b16 v[98:99], v12 offset:4096
    ds_read_b64_tr_b16 v[100:101], v12 offset:64
    ds_read_b64_tr_b16 v[102:103], v12 offset:4160
    ds_read_b64_tr_b16 v[104:105], v12 offset:128
    ds_read_b64_tr_b16 v[106:107], v12 offset:4224
    ds_read_b64_tr_b16 v[108:109], v12 offset:192
    ds_read_b64_tr_b16 v[110:111], v12 offset:4288
    s_waitcnt lgkmcnt(0)
    v_mfma_f32_32x32x16_bf16 v[32:47], v[24:27], v[96:99], 0
    v_mfma_f32_32x32x16_bf16 v[48:63], v[24:27], v[100:103], 0
    v_mfma_f32_32x32x16_bf16 v[64:79], v[24:27], v[104:107], 0
    v_mfma_f32_32x32x16_bf16 v[80:95], v[24:27], v[108:111], 0
    v_add_u32 v12, 256, v12
    s_add_u32 s53, s53, 1
    s_nop 11
    buffer_store_dword v32, v14, s[44:47], s52 offen offset:0 sc1
    buffer_store_dword v48, v14, s[44:47], s52 offen offset:128 sc1
    buffer_store_dword v64, v14, s[44:47], s52 offen offset:256 sc1
    buffer_store_dword v80, v14, s[44:47], s52 offen offset:384 sc1
    s_add_u32 s52, s52, 512
    s_cmp_lt_u32 s53, 4
    s_cbranch_scc1 FFN_DOWN
    s_lshl_b32 s52, s56, 7
    s_add_u32 s52, s52, 327680
    s_waitcnt vmcnt(0)
    s_mov_b64 exec, 1
    buffer_store_dword v3, v2, s[24:27], s52 offen sc1
    s_mov_b64 exec, -1
SYNC_NB1:
    s_barrier
    v_mov_b32 v11, 0x23000
    v_mov_b64 v[102:103], 0
    ds_write_b64 v11, v[102:103] offset:16
    ds_write_b64 v11, v[102:103] offset:24
    ds_write_b32 v11, v102 offset:32
    s_waitcnt lgkmcnt(0)
    buffer_load_dword v12, v6, s[24:27], s41 offen sc1
    s_barrier
    s_mov_b32 s61, 0
    s_mov_b32 s52, 0
SYNC_P:
    ds_read_b32 v13, v11 offset:32
    s_add_u32 s61, s61, 1
    s_waitcnt vmcnt(0) lgkmcnt(0)
    v_cmp_eq_u32 vcc, s60, v12
    v_readfirstlane_b32 s53, v13
    s_cmp_ge_u32 s61, 131072
    s_cselect_b32 s51, 0xff, vcc_lo
    s_and_b32 s51, s51, 0xff
    s_cmp_lg_u32 s52, 0
    s_cbranch_scc1 SYNC_Q
    s_cmp_lt_u32 s53, 8
    s_cbranch_scc1 SYNC_Q
    s_lshl_b32 s52, 1, s19
SYNC_Q:
    s_or_b32 s51, s51, s52
    v_mov_b32 v12, s51
    ds_write_b32 v11, v12 offset:28
    s_cmp_eq_u32 s51, 0xff
    s_cbranch_scc1 SYNC_X
    buffer_load_dword v12, v6, s[24:27], s41 offen sc1
    s_branch SYNC_P
SYNC_X:
    s_waitcnt lgkmcnt(0)
    s_endpgm
AUX_FFN0:
    v_mov_b32 v86, 0x26500
LW_TF:
    ds_read_b32 v84, v86 offset:20
    s_waitcnt lgkmcnt(0)
    v_readfirstlane_b32 s62, v84
    s_cmp_lt_u32 s62, 1
    s_cbranch_scc1 LW_TF
    s_mov_b32 s60, s62
    s_load_dwordx4 s[4:7], s[0:1], 56
    s_load_dwordx2 s[8:9], s[0:1], 72
    s_mul_i32 s54, s2, 2341
    s_lshr_b32 s54, s54, 16
    s_mul_i32 s55, s54, 28
    s_sub_u32 s55, s2, s55
    v_lshrrev_b32 v28, 3, v1
    v_mul_u32_u24 v28, 3584, v28
    v_lshrrev_b32 v6, 2, v1
    v_and_b32 v6, 4, v6
    v_xor_b32 v6, v6, v1
    v_and_b32 v6, 7, v6
    v_lshl_add_u32 v28, v6, 4, v28
    v_lshrrev_b32 v14, 5, v1
    v_lshrrev_b32 v6, 2, v1
    v_and_b32 v6, 3, v6
    v_lshl_add_u32 v13, v14, 3, v6
    v_lshlrev_b32 v12, 10, v13
    v_lshlrev_b32 v13, 7, v13
    v_lshrrev_b32 v6, 1, v6
    v_lshl_add_u32 v13, v6, 6, v13
    v_and_b32 v6, 16, v1
    v_lshlrev_b32 v6, 1, v6
    v_and_b32 v7, 3, v1
    v_lshl_add_u32 v6, v7, 3, v6
    v_add_u32 v13, v13, v6
    v_add_u32 v13, 0x20000, v13
    v_xor_b32 v15, 64, v13
    v_add_u32 v12, v12, v6
    v_add_u32 v12, 0x24000, v12
    v_and_b32 v7, 4, v1
    v_lshlrev_b32 v7, 8, v7
    v_lshl_add_u32 v7, v14, 4, v7
    v_and_b32 v4, 31, v1
    s_waitcnt lgkmcnt(0)
    s_mov_b32 s28, s4
    s_mov_b32 s29, s5
    s_mov_b32 s30, 0x1c0000
    s_mov_b32 s31, 0x00020000
    s_mov_b32 s32, s6
    s_mov_b32 s33, s7
    s_mov_b32 s34, 0x1c0000
    s_mov_b32 s35, 0x00020000
    s_mov_b32 s36, s8
    s_mov_b32 s37, s9
    s_mov_b32 s38, 0x1c0000
    s_mov_b32 s39, 0x00020000
    s_add_u32 s44, s14, 0xa0000
    s_addc_u32 s45, s15, 0
    s_mov_b32 s46, 0x70000
    s_mov_b32 s47, 0x00020000
    s_barrier
    s_cmp_eq_u32 s2, 255
    s_cbranch_scc1 SELECT
    s_barrier
    s_setprio 3
FFN_GO:
    s_cmp_ge_u32 s2, 224
    s_cbranch_scc1 FFN_EXIT
    s_mul_i32 s52, s54, 229376
    s_lshl_b32 s53, s55, 7
    s_add_u32 s52, s52, s53
    s_mov_b32 s53, 131072
    s_mov_b32 s41, 0
FFN_DMA:
    s_mov_b32 m0, s53
    s_add_u32 s53, s53, 1024
    buffer_load_dwordx4 v28, s[28:31], s52 offen lds
    s_add_u32 m0, m0, 8192
    s_add_u32 s41, s41, 1
    buffer_load_dwordx4 v28, s[32:35], s52 offen lds
    s_add_u32 s52, s52, 28672
    s_waitcnt vmcnt(4)
    s_cmp_lt_u32 s41, 8
    s_cbranch_scc1 FFN_DMA
    s_mov_b32 s40, 233472
    s_mov_b32 s61, 0
POLL_FSEL:
    buffer_load_dwordx4 v[20:23], v2, s[24:27], s40 offen sc1
    s_add_u32 s61, s61, 1
    s_waitcnt vmcnt(0)
    v_cmp_ne_u32 vcc, s60, v20
    v_cmp_ne_u32 s[62:63], s60, v23
    s_or_b64 vcc, vcc, s[62:63]
    s_cmp_ge_u32 s61, 131072
    s_cbranch_scc1 POLLX_FSEL
    s_cmp_eq_u64 vcc, 0
    s_cbranch_scc1 POLLX_FSEL
    s_sleep 8
    s_branch POLL_FSEL
POLLX_FSEL:
    s_lshl_b32 s40, s54, 7
    s_add_u32 s40, s40, 234496
    buffer_load_dwordx4 v[16:19], v7, s[24:27], s40 offen offset:0 sc1
    buffer_load_dwordx4 v[20:23], v7, s[24:27], s40 offen offset:32 sc1
    buffer_load_dwordx4 v[24:27], v7, s[24:27], s40 offen offset:64 sc1
    buffer_load_dwordx4 v[28:31], v7, s[24:27], s40 offen offset:96 sc1
    v_mul_u32_u24 v6, 7168, v14
    v_lshl_add_u32 v6, v4, 2, v6
    s_mul_i32 s40, s54, 28672
    s_lshl_b32 s41, s55, 8
    s_add_u32 s40, s40, s41
    s_add_u32 s40, s40, 393216
    s_add_u32 s41, s40, 14336
    s_waitcnt vmcnt(0)
    ds_read_b64_tr_b16 v[96:97], v13 offset:0
    ds_read_b64_tr_b16 v[98:99], v13 offset:512
    ds_read_b64_tr_b16 v[100:101], v13 offset:2048
    ds_read_b64_tr_b16 v[102:103], v13 offset:2560
    ds_read_b64_tr_b16 v[104:105], v13 offset:4096
    ds_read_b64_tr_b16 v[106:107], v13 offset:4608
    ds_read_b64_tr_b16 v[108:109], v13 offset:6144
    ds_read_b64_tr_b16 v[110:111], v13 offset:6656
    ds_read_b64_tr_b16 v[112:113], v15 offset:0
    ds_read_b64_tr_b16 v[114:115], v15 offset:512
    ds_read_b64_tr_b16 v[116:117], v15 offset:2048
    ds_read_b64_tr_b16 v[118:119], v15 offset:2560
    ds_read_b64_tr_b16 v[120:121], v15 offset:4096
    ds_read_b64_tr_b16 v[122:123], v15 offset:4608
    ds_read_b64_tr_b16 v[124:125], v15 offset:6144
    ds_read_b64_tr_b16 v[126:127], v15 offset:6656
    s_waitcnt lgkmcnt(0)
    v_mfma_f32_32x32x16_bf16 v[32:47], v[16:19], v[96:99], 0
    v_mfma_f32_32x32x16_bf16 v[32:47], v[20:23], v[100:103], v[32:47]
    v_mfma_f32_32x32x16_bf16 v[32:47], v[24:27], v[104:107], v[32:47]
    v_mfma_f32_32x32x16_bf16 v[32:47], v[28:31], v[108:111], v[32:47]
    v_mfma_f32_32x32x16_bf16 v[48:63], v[16:19], v[112:115], 0
    v_mfma_f32_32x32x16_bf16 v[48:63], v[20:23], v[116:119], v[48:63]
    v_mfma_f32_32x32x16_bf16 v[48:63], v[24:27], v[120:123], v[48:63]
    v_mfma_f32_32x32x16_bf16 v[48:63], v[28:31], v[124:127], v[48:63]
    ds_read_b64_tr_b16 v[96:97], v13 offset:8192
    ds_read_b64_tr_b16 v[98:99], v13 offset:8704
    ds_read_b64_tr_b16 v[100:101], v13 offset:10240
    ds_read_b64_tr_b16 v[102:103], v13 offset:10752
    ds_read_b64_tr_b16 v[104:105], v13 offset:12288
    ds_read_b64_tr_b16 v[106:107], v13 offset:12800
    ds_read_b64_tr_b16 v[108:109], v13 offset:14336
    ds_read_b64_tr_b16 v[110:111], v13 offset:14848
    ds_read_b64_tr_b16 v[112:113], v15 offset:8192
    ds_read_b64_tr_b16 v[114:115], v15 offset:8704
    ds_read_b64_tr_b16 v[116:117], v15 offset:10240
    ds_read_b64_tr_b16 v[118:119], v15 offset:10752
    ds_read_b64_tr_b16 v[120:121], v15 offset:12288
    ds_read_b64_tr_b16 v[122:123], v15 offset:12800
    ds_read_b64_tr_b16 v[124:125], v15 offset:14336
    ds_read_b64_tr_b16 v[126:127], v15 offset:14848
    s_waitcnt lgkmcnt(0)
    v_mfma_f32_32x32x16_bf16 v[64:79], v[16:19], v[96:99], 0
    v_mfma_f32_32x32x16_bf16 v[64:79], v[20:23], v[100:103], v[64:79]
    v_mfma_f32_32x32x16_bf16 v[64:79], v[24:27], v[104:107], v[64:79]
    v_mfma_f32_32x32x16_bf16 v[64:79], v[28:31], v[108:111], v[64:79]
    v_mfma_f32_32x32x16_bf16 v[80:95], v[16:19], v[112:115], 0
    v_mfma_f32_32x32x16_bf16 v[80:95], v[20:23], v[116:119], v[80:95]
    v_mfma_f32_32x32x16_bf16 v[80:95], v[24:27], v[120:123], v[80:95]
    v_mfma_f32_32x32x16_bf16 v[80:95], v[28:31], v[124:127], v[80:95]
    s_nop 15
    buffer_store_dword v32, v6, s[24:27], s40 offen offset:0 sc1
    buffer_store_dword v48, v6, s[24:27], s40 offen offset:128 sc1
    buffer_store_dword v64, v6, s[24:27], s41 offen offset:0 sc1
    buffer_store_dword v80, v6, s[24:27], s41 offen offset:128 sc1
    s_lshl_b32 s40, s55, 3
    s_add_u32 s40, s40, s54
    s_lshl_b32 s40, s40, 7
    s_add_u32 s40, s40, 360448
    v_mov_b32 v3, s60
    s_waitcnt vmcnt(0)
    s_mov_b64 exec, 1
    buffer_store_dword v3, v2, s[24:27], s40 offen sc1
FFN_EXIT:
    s_endpgm
SELECT:
    s_mov_b32 s40, 229376
    buffer_load_dwordx4 v[64:67], v5, s[24:27], s40 offen sc1
    buffer_load_dwordx4 v[68:71], v5, s[24:27], s40 offen offset:1024 sc1
    s_barrier
    s_setprio 3
    s_waitcnt vmcnt(0)
    v_max3_u32 v16, v64, v65, v66
    v_max3_u32 v17, v67, v68, v69
    v_max3_u32 v16, v70, v71, v16
    v_max_u32 v16, v16, v17
    s_nop 1
    v_max_u32_dpp v16, v16, v16 quad_perm:[1,0,3,2] row_mask:0xf bank_mask:0xf
    s_nop 1
    v_max_u32_dpp v16, v16, v16 quad_perm:[2,3,0,1] row_mask:0xf bank_mask:0xf
    s_nop 1
    v_max_u32_dpp v16, v16, v16 row_half_mirror row_mask:0xf bank_mask:0xf
    s_nop 1
    v_max_u32_dpp v16, v16, v16 row_mirror row_mask:0xf bank_mask:0xf
    s_nop 1
    v_max_u32_dpp v16, v16, v16 row_bcast:15 row_mask:0xa bank_mask:0xf
    s_nop 1
    v_max_u32_dpp v16, v16, v16 row_bcast:31 row_mask:0xc bank_mask:0xf
    s_nop 0
    v_readlane_b32 s48, v16, 63
    s_nop 1
    v_cmp_eq_u32 vcc, s48, v64
    s_nop 1
    v_cndmask_b32 v64, v64, 0, vcc
    v_cmp_eq_u32 vcc, s48, v65
    s_nop 1
    v_cndmask_b32 v65, v65, 0, vcc
    v_cmp_eq_u32 vcc, s48, v66
    s_nop 1
    v_cndmask_b32 v66, v66, 0, vcc
    v_cmp_eq_u32 vcc, s48, v67
    s_nop 1
    v_cndmask_b32 v67, v67, 0, vcc
    v_cmp_eq_u32 vcc, s48, v68
    s_nop 1
    v_cndmask_b32 v68, v68, 0, vcc
    v_cmp_eq_u32 vcc, s48, v69
    s_nop 1
    v_cndmask_b32 v69, v69, 0, vcc
    v_cmp_eq_u32 vcc, s48, v70
    s_nop 1
    v_cndmask_b32 v70, v70, 0, vcc
    v_cmp_eq_u32 vcc, s48, v71
    s_nop 1
    v_cndmask_b32 v71, v71, 0, vcc
    v_max3_u32 v16, v64, v65, v66
    v_max3_u32 v17, v67, v68, v69
    v_max3_u32 v16, v70, v71, v16
    v_max_u32 v16, v16, v17
    s_nop 1
    v_max_u32_dpp v16, v16, v16 quad_perm:[1,0,3,2] row_mask:0xf bank_mask:0xf
    s_nop 1
    v_max_u32_dpp v16, v16, v16 quad_perm:[2,3,0,1] row_mask:0xf bank_mask:0xf
    s_nop 1
    v_max_u32_dpp v16, v16, v16 row_half_mirror row_mask:0xf bank_mask:0xf
    s_nop 1
    v_max_u32_dpp v16, v16, v16 row_mirror row_mask:0xf bank_mask:0xf
    s_nop 1
    v_max_u32_dpp v16, v16, v16 row_bcast:15 row_mask:0xa bank_mask:0xf
    s_nop 1
    v_max_u32_dpp v16, v16, v16 row_bcast:31 row_mask:0xc bank_mask:0xf
    s_nop 0
    v_readlane_b32 s49, v16, 63
    s_nop 1
    s_and_b32 s50, s48, 0xffff
    s_sub_u32 s50, 2047, s50
    s_lshl_b32 s52, s50, 10
    buffer_load_dwordx4 v[64:67], v5, s[20:23], s52 offen
    s_lshl_b32 s52, s50, 4
    s_add_u32 s52, s52, 196608
    buffer_load_dwordx2 v[16:17], v2, s[24:27], s52 offen sc1
    s_and_b32 s51, s49, 0xffff
    s_sub_u32 s51, 2047, s51
    s_lshl_b32 s52, s51, 10
    buffer_load_dwordx4 v[68:71], v5, s[20:23], s52 offen
    s_lshl_b32 s52, s51, 4
    s_add_u32 s52, s52, 196608
    buffer_load_dwordx2 v[18:19], v2, s[24:27], s52 offen sc1
    s_waitcnt vmcnt(0)
    v_lshlrev_b32 v32, 16, v64
    v_and_b32 v33, s42, v64
    v_lshlrev_b32 v34, 16, v65
    v_and_b32 v35, s42, v65
    v_lshlrev_b32 v36, 16, v66
    v_and_b32 v37, s42, v66
    v_lshlrev_b32 v38, 16, v67
    v_and_b32 v39, s42, v67
    v_sub_f32 v20, 0, v16
    v_sub_f32 v21, 0, v16
    v_mov_b32 v22, v17
    v_mov_b32 v23, v17
    v_lshlrev_b32 v40, 16, v68
    v_and_b32 v41, s42, v68
    v_lshlrev_b32 v42, 16, v69
    v_and_b32 v43, s42, v69
    v_lshlrev_b32 v44, 16, v70
    v_and_b32 v45, s42, v70
    v_lshlrev_b32 v46, 16, v71
    v_and_b32 v47, s42, v71
    v_sub_f32 v24, 0, v18
    v_sub_f32 v25, 0, v18
    v_mov_b32 v26, v19
    v_mov_b32 v27, v19
    v_pk_add_f32 v[48:49], v[32:33], v[20:21]
    v_pk_add_f32 v[50:51], v[34:35], v[20:21]
    v_pk_add_f32 v[52:53], v[36:37], v[20:21]
    v_pk_add_f32 v[54:55], v[38:39], v[20:21]
    v_pk_add_f32 v[56:57], v[40:41], v[24:25]
    v_pk_add_f32 v[58:59], v[42:43], v[24:25]
    v_pk_add_f32 v[60:61], v[44:45], v[24:25]
    v_pk_add_f32 v[62:63], v[46:47], v[24:25]
    v_cvt_pk_bf16_f32 v64, v48, v49
    v_cvt_pk_bf16_f32 v65, v50, v51
    v_cvt_pk_bf16_f32 v66, v52, v53
    v_cvt_pk_bf16_f32 v67, v54, v55
    v_cvt_pk_bf16_f32 v68, v56, v57
    v_cvt_pk_bf16_f32 v69, v58, v59
    v_cvt_pk_bf16_f32 v70, v60, v61
    v_cvt_pk_bf16_f32 v71, v62, v63
    v_lshlrev_b32 v48, 16, v64
    v_and_b32 v49, s42, v64
    v_lshlrev_b32 v50, 16, v65
    v_and_b32 v51, s42, v65
    v_lshlrev_b32 v52, 16, v66
    v_and_b32 v53, s42, v66
    v_lshlrev_b32 v54, 16, v67
    v_and_b32 v55, s42, v67
    v_lshlrev_b32 v56, 16, v68
    v_and_b32 v57, s42, v68
    v_lshlrev_b32 v58, 16, v69
    v_and_b32 v59, s42, v69
    v_lshlrev_b32 v60, 16, v70
    v_and_b32 v61, s42, v70
    v_lshlrev_b32 v62, 16, v71
    v_and_b32 v63, s42, v71
    v_pk_mul_f32 v[48:49], v[48:49], v[22:23]
    v_pk_mul_f32 v[50:51], v[50:51], v[22:23]
    v_pk_mul_f32 v[52:53], v[52:53], v[22:23]
    v_pk_mul_f32 v[54:55], v[54:55], v[22:23]
    v_pk_mul_f32 v[56:57], v[56:57], v[26:27]
    v_pk_mul_f32 v[58:59], v[58:59], v[26:27]
    v_pk_mul_f32 v[60:61], v[60:61], v[26:27]
    v_pk_mul_f32 v[62:63], v[62:63], v[26:27]
    v_cvt_pk_bf16_f32 v64, v48, v49
    v_cvt_pk_bf16_f32 v65, v50, v51
    v_cvt_pk_bf16_f32 v66, v52, v53
    v_cvt_pk_bf16_f32 v67, v54, v55
    v_cvt_pk_bf16_f32 v68, v56, v57
    v_cvt_pk_bf16_f32 v69, v58, v59
    v_cvt_pk_bf16_f32 v70, v60, v61
    v_cvt_pk_bf16_f32 v71, v62, v63
    s_mov_b32 s40, 234496
    buffer_store_dwordx4 v[64:67], v5, s[24:27], s40 offen sc1
    buffer_store_dwordx4 v[68:71], v5, s[24:27], s40 offen offset:1024 sc1
    v_mov_b32 v16, s60
    v_mov_b32 v17, s48
    v_mov_b32 v18, s49
    v_mov_b32 v19, s60
    s_mov_b32 s40, 233472
    s_waitcnt vmcnt(0)
    s_mov_b64 exec, 1
    buffer_store_dwordx4 v[16:19], v2, s[24:27], s40 offen sc1
    s_mov_b64 exec, -1
    s_branch FFN_GO
R_LN:
    s_lshl_b32 s43, s19, 3
    s_add_u32 s43, s43, s17
    s_lshl_b32 s44, s16, 1
    s_add_u32 s44, s44, s43
    s_lshl_b32 s45, s44, 10
    s_mul_i32 s40, s16, 2080
    s_add_u32 s40, s40, 147456
    v_add_u32 v3, s40, v5
    v_add_u32 v4, 0x26080, v5
    s_barrier
    v_mov_b32 v86, 0x26500
LW_LN0:
    ds_read_b64 v[84:85], v86 offset:0
    s_waitcnt lgkmcnt(0)
    v_min_u32 v84, v84, v85
    s_nop 0
    v_readfirstlane_b32 s62, v84
    s_cmp_lt_u32 s62, 1
    s_cbranch_scc1 LW_LN0
    v_mov_b32 v104, 0
    ds_read_b128 v[8:11], v3 offset:0
    ds_read_b128 v[12:15], v3 offset:1040
    ds_read_b128 v[24:27], v4
    s_waitcnt lgkmcnt(2)
    v_lshlrev_b32 v32, 16, v8
    v_and_b32 v33, s42, v8
    v_lshlrev_b32 v34, 16, v9
    v_and_b32 v35, s42, v9
    v_lshlrev_b32 v36, 16, v10
    v_and_b32 v37, s42, v10
    v_lshlrev_b32 v38, 16, v11
    v_and_b32 v39, s42, v11
    s_waitcnt lgkmcnt(1)
    v_lshlrev_b32 v40, 16, v12
    v_and_b32 v41, s42, v12
    v_lshlrev_b32 v42, 16, v13
    v_and_b32 v43, s42, v13
    v_lshlrev_b32 v44, 16, v14
    v_and_b32 v45, s42, v14
    v_lshlrev_b32 v46, 16, v15
    v_and_b32 v47, s42, v15
    v_pk_add_f32 v[72:73], v[32:33], v[34:35]
    v_pk_add_f32 v[80:81], v[36:37], v[38:39]
    v_pk_add_f32 v[74:75], v[40:41], v[42:43]
    v_pk_add_f32 v[82:83], v[44:45], v[46:47]
    v_pk_add_f32 v[72:73], v[72:73], v[80:81]
    v_pk_add_f32 v[74:75], v[74:75], v[82:83]
    v_add_f32 v64, v72, v73
    v_add_f32 v65, v74, v75
    s_nop 0
    v_add_f32_dpp v64, v64, v64 quad_perm:[1,0,3,2] row_mask:0xf bank_mask:0xf
    v_add_f32_dpp v65, v65, v65 quad_perm:[1,0,3,2] row_mask:0xf bank_mask:0xf
    s_nop 0
    v_add_f32_dpp v64, v64, v64 quad_perm:[2,3,0,1] row_mask:0xf bank_mask:0xf
    v_add_f32_dpp v65, v65, v65 quad_perm:[2,3,0,1] row_mask:0xf bank_mask:0xf
    s_nop 0
    v_add_f32_dpp v64, v64, v64 row_half_mirror row_mask:0xf bank_mask:0xf
    v_add_f32_dpp v65, v65, v65 row_half_mirror row_mask:0xf bank_mask:0xf
    s_nop 0
    v_add_f32_dpp v64, v64, v64 row_mirror row_mask:0xf bank_mask:0xf
    v_add_f32_dpp v65, v65, v65 row_mirror row_mask:0xf bank_mask:0xf
    s_nop 0
    v_add_f32_dpp v64, v64, v64 row_bcast:15 row_mask:0xa bank_mask:0xf
    v_add_f32_dpp v65, v65, v65 row_bcast:15 row_mask:0xa bank_mask:0xf
    s_nop 0
    v_add_f32_dpp v64, v64, v64 row_bcast:31 row_mask:0xc bank_mask:0xf
    v_add_f32_dpp v65, v65, v65 row_bcast:31 row_mask:0xc bank_mask:0xf
    s_nop 0
    v_readlane_b32 s48, v64, 63
    v_readlane_b32 s49, v65, 63
    v_mov_b32 v68, 0xbb000000
    s_nop 1
    v_mul_f32 v72, s48, v68
    v_mul_f32 v73, s48, v68
    v_mul_f32 v74, s49, v68
    v_mul_f32 v75, s49, v68
    v_pk_add_f32 v[48:49], v[32:33], v[72:73]
    v_pk_add_f32 v[50:51], v[34:35], v[72:73]
    v_pk_add_f32 v[52:53], v[36:37], v[72:73]
    v_pk_add_f32 v[54:55], v[38:39], v[72:73]
    v_pk_add_f32 v[56:57], v[40:41], v[74:75]
    v_pk_add_f32 v[58:59], v[42:43], v[74:75]
    v_pk_add_f32 v[60:61], v[44:45], v[74:75]
    v_pk_add_f32 v[62:63], v[46:47], v[74:75]
    v_pk_mul_f32 v[80:81], v[48:49], v[48:49]
    v_pk_mul_f32 v[82:83], v[56:57], v[56:57]
    v_pk_fma_f32 v[80:81], v[50:51], v[50:51], v[80:81]
    v_pk_fma_f32 v[82:83], v[58:59], v[58:59], v[82:83]
    v_pk_fma_f32 v[80:81], v[52:53], v[52:53], v[80:81]
    v_pk_fma_f32 v[82:83], v[60:61], v[60:61], v[82:83]
    v_pk_fma_f32 v[80:81], v[54:55], v[54:55], v[80:81]
    v_pk_fma_f32 v[82:83], v[62:63], v[62:63], v[82:83]
    v_add_f32 v64, v80, v81
    v_add_f32 v65, v82, v83
    s_nop 0
    v_add_f32_dpp v64, v64, v64 quad_perm:[1,0,3,2] row_mask:0xf bank_mask:0xf
    v_add_f32_dpp v65, v65, v65 quad_perm:[1,0,3,2] row_mask:0xf bank_mask:0xf
    s_nop 0
    v_add_f32_dpp v64, v64, v64 quad_perm:[2,3,0,1] row_mask:0xf bank_mask:0xf
    v_add_f32_dpp v65, v65, v65 quad_perm:[2,3,0,1] row_mask:0xf bank_mask:0xf
    s_nop 0
    v_add_f32_dpp v64, v64, v64 row_half_mirror row_mask:0xf bank_mask:0xf
    v_add_f32_dpp v65, v65, v65 row_half_mirror row_mask:0xf bank_mask:0xf
    s_nop 0
    v_add_f32_dpp v64, v64, v64 row_mirror row_mask:0xf bank_mask:0xf
    v_add_f32_dpp v65, v65, v65 row_mirror row_mask:0xf bank_mask:0xf
    s_nop 0
    v_add_f32_dpp v64, v64, v64 row_bcast:15 row_mask:0xa bank_mask:0xf
    v_add_f32_dpp v65, v65, v65 row_bcast:15 row_mask:0xa bank_mask:0xf
    s_nop 0
    v_add_f32_dpp v64, v64, v64 row_bcast:31 row_mask:0xc bank_mask:0xf
    v_add_f32_dpp v65, v65, v65 row_bcast:31 row_mask:0xc bank_mask:0xf
    s_nop 0
    v_readlane_b32 s52, v64, 63
    v_readlane_b32 s53, v65, 63
    s_nop 1
    v_cvt_pk_bf16_f32 v72, v72, v72
    v_cvt_pk_bf16_f32 v74, v74, v74
    v_and_b32 v73, s42, v72
    v_lshlrev_b32 v72, 16, v72
    v_and_b32 v75, s42, v74
    v_lshlrev_b32 v74, 16, v74
    v_mul_f32 v64, s52, -v68
    v_mul_f32 v65, s53, -v68
    v_cvt_pk_bf16_f32 v66, v64, v65
    v_lshlrev_b32 v64, 16, v66
    v_and_b32 v65, s42, v66
    v_add_f32 v64, 0x3727c5ac, v64
    v_add_f32 v65, 0x3727c5ac, v65
    v_cvt_pk_bf16_f32 v66, v64, v65
    v_lshlrev_b32 v64, 16, v66
    v_and_b32 v65, s42, v66
    v_sqrt_f32 v64, v64
    v_sqrt_f32 v65, v65
    s_nop 0
    v_cvt_pk_bf16_f32 v66, v64, v65
    v_lshlrev_b32 v64, 16, v66
    v_and_b32 v65, s42, v66
    v_rcp_f32 v80, v64
    v_rcp_f32 v82, v65
    s_nop 1
    v_mov_b32 v81, v80
    v_mov_b32 v83, v82
    v_pk_add_f32 v[48:49], v[32:33], v[72:73]
    v_pk_add_f32 v[50:51], v[34:35], v[72:73]
    v_pk_add_f32 v[52:53], v[36:37], v[72:73]
    v_pk_add_f32 v[54:55], v[38:39], v[72:73]
    v_pk_add_f32 v[56:57], v[40:41], v[74:75]
    v_pk_add_f32 v[58:59], v[42:43], v[74:75]
    v_pk_add_f32 v[60:61], v[44:45], v[74:75]
    v_pk_add_f32 v[62:63], v[46:47], v[74:75]
    v_cvt_pk_bf16_f32 v8, v48, v49
    v_cvt_pk_bf16_f32 v9, v50, v51
    v_cvt_pk_bf16_f32 v10, v52, v53
    v_cvt_pk_bf16_f32 v11, v54, v55
    v_cvt_pk_bf16_f32 v12, v56, v57
    v_cvt_pk_bf16_f32 v13, v58, v59
    v_cvt_pk_bf16_f32 v14, v60, v61
    v_cvt_pk_bf16_f32 v15, v62, v63
    v_lshlrev_b32 v48, 16, v8
    v_and_b32 v49, s42, v8
    v_lshlrev_b32 v50, 16, v9
    v_and_b32 v51, s42, v9
    v_lshlrev_b32 v52, 16, v10
    v_and_b32 v53, s42, v10
    v_lshlrev_b32 v54, 16, v11
    v_and_b32 v55, s42, v11
    v_lshlrev_b32 v56, 16, v12
    v_and_b32 v57, s42, v12
    v_lshlrev_b32 v58, 16, v13
    v_and_b32 v59, s42, v13
    v_lshlrev_b32 v60, 16, v14
    v_and_b32 v61, s42, v14
    v_lshlrev_b32 v62, 16, v15
    v_and_b32 v63, s42, v15
    v_pk_mul_f32 v[48:49], v[48:49], v[80:81]
    v_pk_mul_f32 v[50:51], v[50:51], v[80:81]
    v_pk_mul_f32 v[52:53], v[52:53], v[80:81]
    v_pk_mul_f32 v[54:55], v[54:55], v[80:81]
    v_pk_mul_f32 v[56:57], v[56:57], v[82:83]
    v_pk_mul_f32 v[58:59], v[58:59], v[82:83]
    v_pk_mul_f32 v[60:61], v[60:61], v[82:83]
    v_pk_mul_f32 v[62:63], v[62:63], v[82:83]
    v_cvt_pk_bf16_f32 v8, v48, v49
    v_cvt_pk_bf16_f32 v9, v50, v51
    v_cvt_pk_bf16_f32 v10, v52, v53
    v_cvt_pk_bf16_f32 v11, v54, v55
    v_cvt_pk_bf16_f32 v12, v56, v57
    v_cvt_pk_bf16_f32 v13, v58, v59
    v_cvt_pk_bf16_f32 v14, v60, v61
    v_cvt_pk_bf16_f32 v15, v62, v63
    s_waitcnt lgkmcnt(0)
    v_mov_b32 v64, 0
    v_mov_b32 v65, 0
    v_dot2c_f32_bf16 v64, v8, v24
    v_dot2c_f32_bf16 v65, v12, v24
    v_dot2c_f32_bf16 v64, v9, v25
    v_dot2c_f32_bf16 v65, v13, v25
    v_dot2c_f32_bf16 v64, v10, v26
    v_dot2c_f32_bf16 v65, v14, v26
    v_dot2c_f32_bf16 v64, v11, v27
    v_dot2c_f32_bf16 v65, v15, v27
    v_sub_f32 v96, 0, v72
    v_mov_b32 v97, v80
    v_sub_f32 v100, 0, v74
    v_mov_b32 v101, v82
    s_nop 0
    v_add_f32_dpp v64, v64, v64 quad_perm:[1,0,3,2] row_mask:0xf bank_mask:0xf
    v_add_f32_dpp v65, v65, v65 quad_perm:[1,0,3,2] row_mask:0xf bank_mask:0xf
    s_nop 0
    v_add_f32_dpp v64, v64, v64 quad_perm:[2,3,0,1] row_mask:0xf bank_mask:0xf
    v_add_f32_dpp v65, v65, v65 quad_perm:[2,3,0,1] row_mask:0xf bank_mask:0xf
    s_nop 0
    v_add_f32_dpp v64, v64, v64 row_half_mirror row_mask:0xf bank_mask:0xf
    v_add_f32_dpp v65, v65, v65 row_half_mirror row_mask:0xf bank_mask:0xf
    s_nop 0
    v_add_f32_dpp v64, v64, v64 row_mirror row_mask:0xf bank_mask:0xf
    v_add_f32_dpp v65, v65, v65 row_mirror row_mask:0xf bank_mask:0xf
    s_nop 0
    v_add_f32_dpp v64, v64, v64 row_bcast:15 row_mask:0xa bank_mask:0xf
    v_add_f32_dpp v65, v65, v65 row_bcast:15 row_mask:0xa bank_mask:0xf
    s_nop 0
    v_add_f32_dpp v64, v64, v64 row_bcast:31 row_mask:0xc bank_mask:0xf
    v_add_f32_dpp v65, v65, v65 row_bcast:31 row_mask:0xc bank_mask:0xf
    v_cvt_pk_bf16_f32 v66, v64, v65
    v_lshlrev_b32 v64, 16, v66
    v_and_b32 v65, s42, v66
    v_ashrrev_i32 v68, 31, v64
    v_ashrrev_i32 v69, 31, v65
    v_or_b32 v68, 0x80000000, v68
    v_or_b32 v69, 0x80000000, v69
    v_xor_b32 v64, v64, v68
    s_sub_u32 s48, 2047, s44
    v_xor_b32 v65, v65, v69
    s_sub_u32 s49, 2046, s44
    v_and_b32 v64, s42, v64
    v_and_b32 v65, s42, v65
    v_or_b32 v64, s48, v64
    v_or_b32 v65, s49, v65
    s_lshl_b32 s40, s16, 3
    s_add_u32 s40, s40, 156800
    v_mov_b32 v4, s40
    v_cmp_eq_u32 vcc, 63, v1
    ds_write_b128 v3, v[8:11] offset:0
    ds_write_b128 v3, v[12:15] offset:1040
    s_and_saveexec_b64 s[56:57], vcc
    ds_write_b64 v4, v[64:65]
    s_mov_b64 exec, s[56:57]
    v_and_b32 v3, 15, v1
    v_lshrrev_b32 v4, 4, v1
    s_waitcnt lgkmcnt(0)
    v_mov_b32 v6, 1
    s_mov_b64 exec, 1
    ds_add_u32 v86, v6 offset:12
    s_mov_b64 exec, -1
    v_mov_b32 v86, 0x26500
LW_TLN:
    ds_read_b32 v84, v86 offset:20
    s_waitcnt lgkmcnt(0)
    v_readfirstlane_b32 s62, v84
    s_cmp_lt_u32 s62, 1
    s_cbranch_scc1 LW_TLN
    s_mov_b32 s60, s62
    v_mov_b32 v98, s60
    v_mov_b32 v99, s60
    v_mov_b32 v102, s60
    v_mov_b32 v103, s60
    s_lshl_b32 s40, s44, 4
    s_add_u32 s40, s40, 196608
    s_mov_b64 exec, 1
    buffer_store_dwordx4 v[96:99], v104, s[24:27], s40 offen offset:0 sc1
    buffer_store_dwordx4 v[100:103], v104, s[24:27], s40 offen offset:16 sc1
    s_mov_b64 exec, -1
    v_mov_b32 v86, 0x26500
LW_LN1:
    ds_read_b32 v84, v86 offset:12
    s_waitcnt lgkmcnt(0)
    v_readfirstlane_b32 s62, v84
    s_cmp_lt_u32 s62, 4
    s_cbranch_scc1 LW_LN1
    v_mov_b32 v86, 0x26500
LW_LN2:
    ds_read_b64 v[84:85], v86 offset:0
    s_waitcnt lgkmcnt(0)
    v_min_u32 v84, v84, v85
    s_nop 0
    v_readfirstlane_b32 s62, v84
    s_cmp_lt_u32 s62, 2
    s_cbranch_scc1 LW_LN2
    s_cmp_ge_u32 s16, 2
    s_cbranch_scc1 LN_MISC
    v_and_b32 v6, 7, v1
    v_mul_u32_u24 v6, 1040, v6
    v_lshl_add_u32 v6, v4, 4, v6
    v_add_u32 v6, 147456, v6
    v_lshlrev_b32 v7, 8, v4
    v_lshl_add_u32 v7, v3, 3, v7
    s_lshl_b32 s40, s16, 14
    s_add_u32 s40, s40, 114688
    v_add_u32 v7, s40, v7
    s_cmp_eq_u32 s16, 1
    s_cbranch_scc1 LN_V
    ds_read_b128 v[32:35], v6 offset:0
    ds_read_b64_tr_b16 v[64:65], v7 offset:0
    ds_read_b64_tr_b16 v[66:67], v7 offset:128
    ds_read_b128 v[36:39], v6 offset:64
    ds_read_b64_tr_b16 v[68:69], v7 offset:1024
    ds_read_b64_tr_b16 v[70:71], v7 offset:1152
    ds_read_b128 v[40:43], v6 offset:128
    ds_read_b64_tr_b16 v[72:73], v7 offset:2048
    ds_read_b64_tr_b16 v[74:75], v7 offset:2176
    ds_read_b128 v[44:47], v6 offset:192
    ds_read_b64_tr_b16 v[76:77], v7 offset:3072
    ds_read_b64_tr_b16 v[78:79], v7 offset:3200
    ds_read_b128 v[48:51], v6 offset:256
    ds_read_b64_tr_b16 v[80:81], v7 offset:4096
    ds_read_b64_tr_b16 v[82:83], v7 offset:4224
    ds_read_b128 v[52:55], v6 offset:320
    ds_read_b64_tr_b16 v[84:85], v7 offset:5120
    ds_read_b64_tr_b16 v[86:87], v7 offset:5248
    ds_read_b128 v[56:59], v6 offset:384
    ds_read_b64_tr_b16 v[88:89], v7 offset:6144
    ds_read_b64_tr_b16 v[90:91], v7 offset:6272
    ds_read_b128 v[60:63], v6 offset:448
    ds_read_b64_tr_b16 v[92:93], v7 offset:7168
    ds_read_b64_tr_b16 v[94:95], v7 offset:7296
    s_waitcnt lgkmcnt(12)
    v_mfma_f32_16x16x32_bf16 v[8:11], v[64:67], v[32:35], 0
    v_mfma_f32_16x16x32_bf16 v[8:11], v[68:71], v[36:39], v[8:11]
    v_mfma_f32_16x16x32_bf16 v[8:11], v[72:75], v[40:43], v[8:11]
    v_mfma_f32_16x16x32_bf16 v[8:11], v[76:79], v[44:47], v[8:11]
    s_waitcnt lgkmcnt(0)
    v_mfma_f32_16x16x32_bf16 v[8:11], v[80:83], v[48:51], v[8:11]
    v_mfma_f32_16x16x32_bf16 v[8:11], v[84:87], v[52:55], v[8:11]
    v_mfma_f32_16x16x32_bf16 v[8:11], v[88:91], v[56:59], v[8:11]
    v_mfma_f32_16x16x32_bf16 v[8:11], v[92:95], v[60:63], v[8:11]
    s_nop 7
    ds_read_b128 v[32:35], v6 offset:512
    ds_read_b64_tr_b16 v[64:65], v7 offset:8192
    ds_read_b64_tr_b16 v[66:67], v7 offset:8320
    ds_read_b128 v[36:39], v6 offset:576
    ds_read_b64_tr_b16 v[68:69], v7 offset:9216
    ds_read_b64_tr_b16 v[70:71], v7 offset:9344
    ds_read_b128 v[40:43], v6 offset:640
    ds_read_b64_tr_b16 v[72:73], v7 offset:10240
    ds_read_b64_tr_b16 v[74:75], v7 offset:10368
    ds_read_b128 v[44:47], v6 offset:704
    ds_read_b64_tr_b16 v[76:77], v7 offset:11264
    ds_read_b64_tr_b16 v[78:79], v7 offset:11392
    ds_read_b128 v[48:51], v6 offset:768
    ds_read_b64_tr_b16 v[80:81], v7 offset:12288
    ds_read_b64_tr_b16 v[82:83], v7 offset:12416
    ds_read_b128 v[52:55], v6 offset:832
    ds_read_b64_tr_b16 v[84:85], v7 offset:13312
    ds_read_b64_tr_b16 v[86:87], v7 offset:13440
    ds_read_b128 v[56:59], v6 offset:896
    ds_read_b64_tr_b16 v[88:89], v7 offset:14336
    ds_read_b64_tr_b16 v[90:91], v7 offset:14464
    ds_read_b128 v[60:63], v6 offset:960
    ds_read_b64_tr_b16 v[92:93], v7 offset:15360
    ds_read_b64_tr_b16 v[94:95], v7 offset:15488
    s_waitcnt lgkmcnt(12)
    v_mfma_f32_16x16x32_bf16 v[8:11], v[64:67], v[32:35], v[8:11]
    v_mfma_f32_16x16x32_bf16 v[8:11], v[68:71], v[36:39], v[8:11]
    v_mfma_f32_16x16x32_bf16 v[8:11], v[72:75], v[40:43], v[8:11]
    v_mfma_f32_16x16x32_bf16 v[8:11], v[76:79], v[44:47], v[8:11]
    s_waitcnt lgkmcnt(0)
    v_mfma_f32_16x16x32_bf16 v[8:11], v[80:83], v[48:51], v[8:11]
    v_mfma_f32_16x16x32_bf16 v[8:11], v[84:87], v[52:55], v[8:11]
    v_mfma_f32_16x16x32_bf16 v[8:11], v[88:91], v[56:59], v[8:11]
    v_mfma_f32_16x16x32_bf16 v[8:11], v[92:95], v[60:63], v[8:11]
    s_nop 7
    v_lshrrev_b32 v7, 1, v4
    v_lshl_add_u32 v7, v7, 5, v3
    v_lshlrev_b32 v7, 4, v7
    v_and_b32 v14, 1, v4
    v_lshl_add_u32 v7, v14, 3, v7
    s_lshr_b32 s40, s43, 5
    s_lshl_b32 s40, s40, 10
    s_and_b32 s41, s43, 31
    s_lshl_b32 s41, s41, 4
    s_add_u32 s40, s40, s41
    v_cmp_gt_u32 vcc, 8, v3
    v_cvt_pk_bf16_f32 v12, v8, v9
    v_cvt_pk_bf16_f32 v13, v10, v11
    s_and_saveexec_b64 s[56:57], vcc
    buffer_store_dwordx2 v[12:13], v7, s[24:27], s40 offen sc1
    s_mov_b64 exec, s[56:57]
    s_branch LN_DONE
LN_V:
    ds_read_b128 v[32:35], v6 offset:0
    ds_read_b64_tr_b16 v[64:65], v7 offset:0
    ds_read_b64_tr_b16 v[66:67], v7 offset:128
    ds_read_b128 v[36:39], v6 offset:64
    ds_read_b64_tr_b16 v[68:69], v7 offset:1024
    ds_read_b64_tr_b16 v[70:71], v7 offset:1152
    ds_read_b128 v[40:43], v6 offset:128
    ds_read_b64_tr_b16 v[72:73], v7 offset:2048
    ds_read_b64_tr_b16 v[74:75], v7 offset:2176
    ds_read_b128 v[44:47], v6 offset:192
    ds_read_b64_tr_b16 v[76:77], v7 offset:3072
    ds_read_b64_tr_b16 v[78:79], v7 offset:3200
    ds_read_b128 v[48:51], v6 offset:256
    ds_read_b64_tr_b16 v[80:81], v7 offset:4096
    ds_read_b64_tr_b16 v[82:83], v7 offset:4224
    ds_read_b128 v[52:55], v6 offset:320
    ds_read_b64_tr_b16 v[84:85], v7 offset:5120
    ds_read_b64_tr_b16 v[86:87], v7 offset:5248
    ds_read_b128 v[56:59], v6 offset:384
    ds_read_b64_tr_b16 v[88:89], v7 offset:6144
    ds_read_b64_tr_b16 v[90:91], v7 offset:6272
    ds_read_b128 v[60:63], v6 offset:448
    ds_read_b64_tr_b16 v[92:93], v7 offset:7168
    ds_read_b64_tr_b16 v[94:95], v7 offset:7296
    s_waitcnt lgkmcnt(12)
    v_mfma_f32_16x16x32_bf16 v[8:11], v[32:35], v[64:67], 0
    v_mfma_f32_16x16x32_bf16 v[8:11], v[36:39], v[68:71], v[8:11]
    v_mfma_f32_16x16x32_bf16 v[8:11], v[40:43], v[72:75], v[8:11]
    v_mfma_f32_16x16x32_bf16 v[8:11], v[44:47], v[76:79], v[8:11]
    s_waitcnt lgkmcnt(0)
    v_mfma_f32_16x16x32_bf16 v[8:11], v[48:51], v[80:83], v[8:11]
    v_mfma_f32_16x16x32_bf16 v[8:11], v[52:55], v[84:87], v[8:11]
    v_mfma_f32_16x16x32_bf16 v[8:11], v[56:59], v[88:91], v[8:11]
    v_mfma_f32_16x16x32_bf16 v[8:11], v[60:63], v[92:95], v[8:11]
    s_nop 7
    ds_read_b128 v[32:35], v6 offset:512
    ds_read_b64_tr_b16 v[64:65], v7 offset:8192
    ds_read_b64_tr_b16 v[66:67], v7 offset:8320
    ds_read_b128 v[36:39], v6 offset:576
    ds_read_b64_tr_b16 v[68:69], v7 offset:9216
    ds_read_b64_tr_b16 v[70:71], v7 offset:9344
    ds_read_b128 v[40:43], v6 offset:640
    ds_read_b64_tr_b16 v[72:73], v7 offset:10240
    ds_read_b64_tr_b16 v[74:75], v7 offset:10368
    ds_read_b128 v[44:47], v6 offset:704
    ds_read_b64_tr_b16 v[76:77], v7 offset:11264
    ds_read_b64_tr_b16 v[78:79], v7 offset:11392
    ds_read_b128 v[48:51], v6 offset:768
    ds_read_b64_tr_b16 v[80:81], v7 offset:12288
    ds_read_b64_tr_b16 v[82:83], v7 offset:12416
    ds_read_b128 v[52:55], v6 offset:832
    ds_read_b64_tr_b16 v[84:85], v7 offset:13312
    ds_read_b64_tr_b16 v[86:87], v7 offset:13440
    ds_read_b128 v[56:59], v6 offset:896
    ds_read_b64_tr_b16 v[88:89], v7 offset:14336
    ds_read_b64_tr_b16 v[90:91], v7 offset:14464
    ds_read_b128 v[60:63], v6 offset:960
    ds_read_b64_tr_b16 v[92:93], v7 offset:15360
    ds_read_b64_tr_b16 v[94:95], v7 offset:15488
    s_waitcnt lgkmcnt(12)
    v_mfma_f32_16x16x32_bf16 v[8:11], v[32:35], v[64:67], v[8:11]
    v_mfma_f32_16x16x32_bf16 v[8:11], v[36:39], v[68:71], v[8:11]
    v_mfma_f32_16x16x32_bf16 v[8:11], v[40:43], v[72:75], v[8:11]
    v_mfma_f32_16x16x32_bf16 v[8:11], v[44:47], v[76:79], v[8:11]
    s_waitcnt lgkmcnt(0)
    v_mfma_f32_16x16x32_bf16 v[8:11], v[48:51], v[80:83], v[8:11]
    v_mfma_f32_16x16x32_bf16 v[8:11], v[52:55], v[84:87], v[8:11]
    v_mfma_f32_16x16x32_bf16 v[8:11], v[56:59], v[88:91], v[8:11]
    v_mfma_f32_16x16x32_bf16 v[8:11], v[60:63], v[92:95], v[8:11]
    s_nop 7
    v_and_b32 v7, 3, v3
    v_and_b32 v14, 4, v3
    v_lshl_add_u32 v7, v14, 1, v7
    v_lshrrev_b32 v14, 3, v3
    v_lshl_add_u32 v7, v14, 2, v7
    v_lshlrev_b32 v7, 4, v7
    v_lshl_add_u32 v7, v4, 3, v7
    s_lshr_b32 s40, s43, 4
    s_lshl_b32 s40, s40, 10
    s_and_b32 s41, s43, 8
    s_lshl_b32 s41, s41, 6
    s_add_u32 s40, s40, s41
    s_add_u32 s40, s40, 65536
    v_cmp_gt_u32 vcc, 32, v1
    v_cvt_pk_bf16_f32 v12, v8, v9
    v_cvt_pk_bf16_f32 v13, v10, v11
    s_and_saveexec_b64 s[56:57], vcc
    buffer_store_dwordx2 v[12:13], v7, s[24:27], s40 offen sc1
    s_mov_b64 exec, s[56:57]
    s_branch LN_DONE
LN_MISC:
    s_cmp_eq_u32 s16, 2
    s_cbranch_scc1 LN_TOP
    v_add_u32 v6, 16, v1
    v_lshlrev_b32 v6, 4, v6
    v_and_b32 v7, 11, v1
    v_mov_b32 v8, 0x3f803f80
    v_cmp_eq_u32 vcc, 0, v7
    s_lshr_b32 s40, s43, 4
    s_lshl_b32 s40, s40, 10
    v_cndmask_b32 v8, 0, v8, vcc
    v_mov_b32 v9, v8
    v_mov_b32 v10, v8
    v_mov_b32 v11, v8
    s_and_b32 s41, s43, 8
    s_lshl_b32 s41, s41, 6
    s_add_u32 s40, s40, s41
    s_add_u32 s40, s40, 65536
    v_cmp_gt_u32 vcc, 16, v1
    s_and_saveexec_b64 s[56:57], vcc
    buffer_store_dwordx4 v[8:11], v6, s[24:27], s40 offen sc1
    s_mov_b64 exec, s[56:57]
    s_branch LN_MISC2
LN_TOP:
    v_and_b32 v3, 7, v1
    v_lshlrev_b32 v3, 2, v3
    v_add_u32 v3, 0x26480, v3
    ds_read_b32 v8, v3
    s_waitcnt lgkmcnt(0)
    v_mov_b32 v10, v8
    s_nop 1
    v_max_u32_dpp v10, v10, v10 quad_perm:[1,0,3,2] row_mask:0xf bank_mask:0xf
    s_nop 1
    v_max_u32_dpp v10, v10, v10 quad_perm:[2,3,0,1] row_mask:0xf bank_mask:0xf
    s_nop 1
    v_max_u32_dpp v10, v10, v10 row_half_mirror row_mask:0xf bank_mask:0xf
    v_cmp_eq_u32 vcc, v8, v10
    s_nop 1
    v_cndmask_b32 v11, v8, 0, vcc
    s_nop 1
    v_max_u32_dpp v11, v11, v11 quad_perm:[1,0,3,2] row_mask:0xf bank_mask:0xf
    s_nop 1
    v_max_u32_dpp v11, v11, v11 quad_perm:[2,3,0,1] row_mask:0xf bank_mask:0xf
    s_nop 1
    v_max_u32_dpp v11, v11, v11 row_half_mirror row_mask:0xf bank_mask:0xf
    s_lshl_b32 s40, s2, 3
    s_add_u32 s40, s40, 229376
    v_mov_b32 v3, 0
    v_cmp_eq_u32 vcc, 0, v1
    s_and_saveexec_b64 s[56:57], vcc
    buffer_store_dwordx2 v[10:11], v3, s[24:27], s40 offen sc1
    s_mov_b64 exec, s[56:57]
LN_MISC2:
LN_DONE:
    s_getreg_b32 s59, hwreg(HW_REG_XCC_ID)
    v_mov_b32 v8, s60
    v_mov_b32 v9, s59
    v_mov_b32 v6, 0x26500
    v_mov_b32 v7, 1
    s_lshl_b32 s40, s2, 7
    s_add_u32 s40, s40, 262144
    s_waitcnt vmcnt(0) lgkmcnt(0)
    s_mov_b64 exec, 1
    ds_add_rtn_u32 v7, v6, v7 offset:16
    s_waitcnt lgkmcnt(0)
    v_readfirstlane_b32 s41, v7
    s_cmp_lg_u32 s41, 3
    s_cbranch_scc1 LN_NOFLAG
    buffer_store_dwordx2 v[8:9], v104, s[24:27], s40 offen sc1
LN_NOFLAG:
    s_mov_b64 exec, -1
    s_load_dwordx2 s[68:69], s[0:1], 80
    s_lshr_b32 s64, s16, 1
    s_lshl_b32 s64, s64, 5
    s_add_u32 s64, s64, s17
    s_and_b32 s40, s16, 1
    s_lshl_b32 s40, s40, 5
    s_add_u32 s40, s40, s18
    s_lshl_b32 s65, s64, 10
    s_lshl_b32 s40, s40, 1
    s_add_u32 s65, s65, s40
    s_add_u32 s66, s65, 16384
    v_lshrrev_b32 v144, 2, v1
    v_and_b32 v145, 3, v1
    v_lshlrev_b32 v146, 10, v144
    v_lshl_add_u32 v146, v145, 4, v146
    buffer_load_dwordx4 v[128:131], v146, s[20:23], s65 offen
    buffer_load_dwordx4 v[132:135], v146, s[20:23], s66 offen
    v_lshlrev_b32 v48, 4, v144
    s_lshl_b32 s40, s64, 4
    s_add_u32 s40, s40, 196608
    s_mov_b32 s61, 0
POLL_PS0:
    buffer_load_dwordx4 v[20:23], v48, s[24:27], s40 offen sc1
    s_add_u32 s61, s61, 1
    s_waitcnt vmcnt(0)
    v_cmp_ne_u32 vcc, s60, v22
    v_cmp_ne_u32 s[62:63], s60, v23
    s_or_b64 vcc, vcc, s[62:63]
    s_cmp_ge_u32 s61, 131072
    s_cbranch_scc1 POLLX_PS0
    s_cmp_eq_u64 vcc, 0
    s_cbranch_scc1 POLLX_PS0
    s_sleep 2
    s_branch POLL_PS0
POLLX_PS0:
    v_mov_b64 v[148:149], v[20:21]
    s_add_u32 s40, s40, 256
    s_mov_b32 s61, 0
POLL_PS1:
    buffer_load_dwordx4 v[20:23], v48, s[24:27], s40 offen sc1
    s_add_u32 s61, s61, 1
    s_waitcnt vmcnt(0)
    v_cmp_ne_u32 vcc, s60, v22
    v_cmp_ne_u32 s[62:63], s60, v23
    s_or_b64 vcc, vcc, s[62:63]
    s_cmp_ge_u32 s61, 131072
    s_cbranch_scc1 POLLX_PS1
    s_cmp_eq_u64 vcc, 0
    s_cbranch_scc1 POLLX_PS1
    s_sleep 2
    s_branch POLL_PS1
POLLX_PS1:
    v_mov_b64 v[150:151], v[20:21]
    s_add_u32 s40, s40, 256
    v_mov_b64 v[160:161], v[128:129]
    v_mov_b64 v[162:163], v[130:131]
    v_mov_b64 v[164:165], v[132:133]
    v_mov_b64 v[166:167], v[134:135]
    v_lshlrev_b32 v112, 16, v128
    v_and_b32 v113, s42, v128
    v_lshlrev_b32 v114, 16, v129
    v_and_b32 v115, s42, v129
    v_lshlrev_b32 v116, 16, v130
    v_and_b32 v117, s42, v130
    v_lshlrev_b32 v118, 16, v131
    v_and_b32 v119, s42, v131
    v_lshlrev_b32 v120, 16, v132
    v_and_b32 v121, s42, v132
    v_lshlrev_b32 v122, 16, v133
    v_and_b32 v123, s42, v133
    v_lshlrev_b32 v124, 16, v134
    v_and_b32 v125, s42, v134
    v_lshlrev_b32 v126, 16, v135
    v_and_b32 v127, s42, v135
    v_sub_f32 v136, 0, v148
    v_sub_f32 v137, 0, v148
    v_mov_b32 v138, v149
    v_mov_b32 v139, v149
    v_sub_f32 v140, 0, v150
    v_sub_f32 v141, 0, v150
    v_mov_b32 v142, v151
    v_mov_b32 v143, v151
    v_pk_add_f32 v[96:97], v[112:113], v[136:137]
    v_pk_add_f32 v[98:99], v[114:115], v[136:137]
    v_pk_add_f32 v[100:101], v[116:117], v[136:137]
    v_pk_add_f32 v[102:103], v[118:119], v[136:137]
    v_pk_add_f32 v[104:105], v[120:121], v[140:141]
    v_pk_add_f32 v[106:107], v[122:123], v[140:141]
    v_pk_add_f32 v[108:109], v[124:125], v[140:141]
    v_pk_add_f32 v[110:111], v[126:127], v[140:141]
    v_cvt_pk_bf16_f32 v128, v96, v97
    v_cvt_pk_bf16_f32 v129, v98, v99
    v_cvt_pk_bf16_f32 v130, v100, v101
    v_cvt_pk_bf16_f32 v131, v102, v103
    v_cvt_pk_bf16_f32 v132, v104, v105
    v_cvt_pk_bf16_f32 v133, v106, v107
    v_cvt_pk_bf16_f32 v134, v108, v109
    v_cvt_pk_bf16_f32 v135, v110, v111
    v_lshlrev_b32 v96, 16, v128
    v_and_b32 v97, s42, v128
    v_lshlrev_b32 v98, 16, v129
    v_and_b32 v99, s42, v129
    v_lshlrev_b32 v100, 16, v130
    v_and_b32 v101, s42, v130
    v_lshlrev_b32 v102, 16, v131
    v_and_b32 v103, s42, v131
    v_lshlrev_b32 v104, 16, v132
    v_and_b32 v105, s42, v132
    v_lshlrev_b32 v106, 16, v133
    v_and_b32 v107, s42, v133
    v_lshlrev_b32 v108, 16, v134
    v_and_b32 v109, s42, v134
    v_lshlrev_b32 v110, 16, v135
    v_and_b32 v111, s42, v135
    v_pk_mul_f32 v[96:97], v[96:97], v[138:139]
    v_pk_mul_f32 v[98:99], v[98:99], v[138:139]
    v_pk_mul_f32 v[100:101], v[100:101], v[138:139]
    v_pk_mul_f32 v[102:103], v[102:103], v[138:139]
    v_pk_mul_f32 v[104:105], v[104:105], v[142:143]
    v_pk_mul_f32 v[106:107], v[106:107], v[142:143]
    v_pk_mul_f32 v[108:109], v[108:109], v[142:143]
    v_pk_mul_f32 v[110:111], v[110:111], v[142:143]
    v_cvt_pk_bf16_f32 v128, v96, v97
    v_cvt_pk_bf16_f32 v129, v98, v99
    v_cvt_pk_bf16_f32 v130, v100, v101
    v_cvt_pk_bf16_f32 v131, v102, v103
    v_cvt_pk_bf16_f32 v132, v104, v105
    v_cvt_pk_bf16_f32 v133, v106, v107
    v_cvt_pk_bf16_f32 v134, v108, v109
    v_cvt_pk_bf16_f32 v135, v110, v111
    v_lshlrev_b32 v96, 16, v128
    v_and_b32 v97, s42, v128
    v_lshlrev_b32 v98, 16, v129
    v_and_b32 v99, s42, v129
    v_lshlrev_b32 v100, 16, v130
    v_and_b32 v101, s42, v130
    v_lshlrev_b32 v102, 16, v131
    v_and_b32 v103, s42, v131
    v_lshlrev_b32 v104, 16, v132
    v_and_b32 v105, s42, v132
    v_lshlrev_b32 v106, 16, v133
    v_and_b32 v107, s42, v133
    v_lshlrev_b32 v108, 16, v134
    v_and_b32 v109, s42, v134
    v_lshlrev_b32 v110, 16, v135
    v_and_b32 v111, s42, v135
    v_mul_f32 v48, 0xbfb8aa3b, v96
    v_mul_f32 v49, 0xbfb8aa3b, v97
    v_mul_f32 v50, 0xbfb8aa3b, v98
    v_mul_f32 v51, 0xbfb8aa3b, v99
    v_mul_f32 v52, 0xbfb8aa3b, v100
    v_mul_f32 v53, 0xbfb8aa3b, v101
    v_mul_f32 v54, 0xbfb8aa3b, v102
    v_mul_f32 v55, 0xbfb8aa3b, v103
    v_mul_f32 v56, 0xbfb8aa3b, v104
    v_mul_f32 v57, 0xbfb8aa3b, v105
    v_mul_f32 v58, 0xbfb8aa3b, v106
    v_mul_f32 v59, 0xbfb8aa3b, v107
    v_mul_f32 v60, 0xbfb8aa3b, v108
    v_mul_f32 v61, 0xbfb8aa3b, v109
    v_mul_f32 v62, 0xbfb8aa3b, v110
    v_mul_f32 v63, 0xbfb8aa3b, v111
    v_exp_f32 v48, v48
    v_exp_f32 v49, v49
    v_exp_f32 v50, v50
    v_exp_f32 v51, v51
    v_exp_f32 v52, v52
    v_exp_f32 v53, v53
    v_exp_f32 v54, v54
    v_exp_f32 v55, v55
    v_exp_f32 v56, v56
    v_exp_f32 v57, v57
    v_exp_f32 v58, v58
    v_exp_f32 v59, v59
    v_exp_f32 v60, v60
    v_exp_f32 v61, v61
    v_exp_f32 v62, v62
    v_exp_f32 v63, v63
    v_add_f32 v48, 1.0, v48
    v_add_f32 v49, 1.0, v49
    v_add_f32 v50, 1.0, v50
    v_add_f32 v51, 1.0, v51
    v_add_f32 v52, 1.0, v52
    v_add_f32 v53, 1.0, v53
    v_add_f32 v54, 1.0, v54
    v_add_f32 v55, 1.0, v55
    v_add_f32 v56, 1.0, v56
    v_add_f32 v57, 1.0, v57
    v_add_f32 v58, 1.0, v58
    v_add_f32 v59, 1.0, v59
    v_add_f32 v60, 1.0, v60
    v_add_f32 v61, 1.0, v61
    v_add_f32 v62, 1.0, v62
    v_add_f32 v63, 1.0, v63
    v_rcp_f32 v48, v48
    v_rcp_f32 v49, v49
    v_rcp_f32 v50, v50
    v_rcp_f32 v51, v51
    v_rcp_f32 v52, v52
    v_rcp_f32 v53, v53
    v_rcp_f32 v54, v54
    v_rcp_f32 v55, v55
    v_rcp_f32 v56, v56
    v_rcp_f32 v57, v57
    v_rcp_f32 v58, v58
    v_rcp_f32 v59, v59
    v_rcp_f32 v60, v60
    v_rcp_f32 v61, v61
    v_rcp_f32 v62, v62
    v_rcp_f32 v63, v63
    v_pk_mul_f32 v[96:97], v[96:97], v[48:49]
    v_pk_mul_f32 v[98:99], v[98:99], v[50:51]
    v_pk_mul_f32 v[100:101], v[100:101], v[52:53]
    v_pk_mul_f32 v[102:103], v[102:103], v[54:55]
    v_pk_mul_f32 v[104:105], v[104:105], v[56:57]
    v_pk_mul_f32 v[106:107], v[106:107], v[58:59]
    v_pk_mul_f32 v[108:109], v[108:109], v[60:61]
    v_pk_mul_f32 v[110:111], v[110:111], v[62:63]
    v_cvt_pk_bf16_f32 v152, v96, v97
    v_cvt_pk_bf16_f32 v153, v98, v99
    v_cvt_pk_bf16_f32 v154, v100, v101
    v_cvt_pk_bf16_f32 v155, v102, v103
    v_cvt_pk_bf16_f32 v156, v104, v105
    v_cvt_pk_bf16_f32 v157, v106, v107
    v_cvt_pk_bf16_f32 v158, v108, v109
    v_cvt_pk_bf16_f32 v159, v110, v111
    s_mov_b32 s46, 0
    s_branch ATT
R_GEMM:
    v_lshrrev_b32 v3, 5, v1
    v_lshrrev_b32 v5, 2, v1
    v_and_b32 v5, 3, v5
    v_lshl_add_u32 v6, v3, 3, v5
    v_lshlrev_b32 v6, 7, v6
    v_lshrrev_b32 v7, 1, v5
    s_and_b32 s40, s16, 1
    v_xor_b32 v7, s40, v7
    v_lshl_add_u32 v6, v7, 6, v6
    v_and_b32 v7, 16, v1
    v_lshl_add_u32 v6, v7, 1, v6
    v_and_b32 v7, 1, v1
    v_lshl_add_u32 v6, v7, 4, v6
    v_and_b32 v7, 2, v1
    v_lshl_add_u32 v6, v7, 2, v6
    v_add_u32 v6, 0xe000, v6
    v_and_b32 v2, 31, v1
    v_lshrrev_b32 v5, 1, v2
    v_and_b32 v5, 7, v5
    v_xor_b32 v5, v5, v3
    v_lshlrev_b32 v2, 7, v2
    v_lshl_add_u32 v2, v5, 4, v2
    s_lshr_b32 s40, s16, 1
    s_lshl_b32 s40, s40, 12
    v_add_u32 v10, s40, v2
    v_xor_b32 v11, 32, v10
    v_xor_b32 v12, 64, v10
    v_xor_b32 v13, 96, v10
    v_mov_b64 v[48:49], 0
    v_mov_b64 v[50:51], 0
    v_mov_b64 v[52:53], 0
    v_mov_b64 v[54:55], 0
    v_mov_b64 v[56:57], 0
    v_mov_b64 v[58:59], 0
    v_mov_b64 v[60:61], 0
    v_mov_b64 v[62:63], 0
    v_mov_b64 v[64:65], 0
    v_mov_b64 v[66:67], 0
    v_mov_b64 v[68:69], 0
    v_mov_b64 v[70:71], 0
    v_mov_b64 v[72:73], 0
    v_mov_b64 v[74:75], 0
    v_mov_b64 v[76:77], 0
    v_mov_b64 v[78:79], 0
    v_mov_b32 v80, 0x3f803f80
    v_mov_b32 v81, 0x3f803f80
    v_mov_b32 v82, 0x3f803f80
    v_mov_b32 v83, 0x3f803f80
    v_mov_b32 v7, 1
    s_mov_b32 s41, 3
    s_barrier
    v_mov_b32 v86, 0x26500
LW_G0:
    ds_read_b64 v[84:85], v86 offset:0
    s_waitcnt lgkmcnt(0)
    v_min_u32 v84, v84, v85
    s_nop 0
    v_readfirstlane_b32 s62, v84
    s_cmp_lt_u32 s62, s41
    s_cbranch_scc1 LW_G0
    ds_read_b64_tr_b16 v[16:17], v6 offset:0
    ds_read_b64_tr_b16 v[18:19], v6 offset:512
    ds_read_b128 v[20:23], v10
    ds_read_b64_tr_b16 v[24:25], v6 offset:2048
    ds_read_b64_tr_b16 v[26:27], v6 offset:2560
    ds_read_b128 v[28:31], v11
    ds_read_b64_tr_b16 v[32:33], v6 offset:4096
    ds_read_b64_tr_b16 v[34:35], v6 offset:4608
    ds_read_b128 v[36:39], v12
    ds_read_b64_tr_b16 v[40:41], v6 offset:6144
    ds_read_b64_tr_b16 v[42:43], v6 offset:6656
    ds_read_b128 v[44:47], v13
    s_movk_i32 s40, 0x2000
    s_cmp_eq_u32 s41, 9
    s_cselect_b32 s40, 4294918144, s40
    v_add_u32 v6, s40, v6
    v_add_u32 v10, s40, v10
    v_add_u32 v11, s40, v11
    v_add_u32 v12, s40, v12
    v_add_u32 v13, s40, v13
    s_add_u32 s41, s41, 1
GL_P1:
    s_cmp_ge_u32 s62, s41
    s_cbranch_scc1 GL_S1
    v_mov_b32 v86, 0x26500
LW_G1:
    ds_read_b64 v[84:85], v86 offset:0
    s_waitcnt lgkmcnt(0)
    v_min_u32 v84, v84, v85
    s_nop 0
    v_readfirstlane_b32 s62, v84
    s_cmp_lt_u32 s62, s41
    s_cbranch_scc1 LW_G1
GL_S1:
    ds_read_b64_tr_b16 v[88:89], v6 offset:0
    ds_read_b64_tr_b16 v[90:91], v6 offset:512
    ds_read_b128 v[92:95], v10
    ds_read_b64_tr_b16 v[96:97], v6 offset:2048
    ds_read_b64_tr_b16 v[98:99], v6 offset:2560
    ds_read_b128 v[100:103], v11
    ds_read_b64_tr_b16 v[104:105], v6 offset:4096
    ds_read_b64_tr_b16 v[106:107], v6 offset:4608
    ds_read_b128 v[108:111], v12
    ds_read_b64_tr_b16 v[112:113], v6 offset:6144
    ds_read_b64_tr_b16 v[114:115], v6 offset:6656
    ds_read_b128 v[116:119], v13
    s_movk_i32 s40, 0x2000
    s_cmp_eq_u32 s41, 9
    s_cselect_b32 s40, 4294918144, s40
    v_add_u32 v6, s40, v6
    v_add_u32 v10, s40, v10
    v_add_u32 v11, s40, v11
    v_add_u32 v12, s40, v12
    v_add_u32 v13, s40, v13
    s_add_u32 s41, s41, 1
    s_waitcnt lgkmcnt(12)
    s_cmp_lg_u32 s41, 5
    s_cbranch_scc1 GL_NOSIG
    s_mov_b64 exec, 1
    ds_add_u32 v86, v7 offset:8
    s_mov_b64 exec, -1
GL_NOSIG:
    v_mfma_f32_32x32x16_bf16 v[48:63], v[16:19], v[20:23], v[48:63]
    v_mfma_f32_32x32x16_bf16 v[64:79], v[16:19], v[80:83], v[64:79]
    v_mfma_f32_32x32x16_bf16 v[48:63], v[24:27], v[28:31], v[48:63]
    v_mfma_f32_32x32x16_bf16 v[64:79], v[24:27], v[80:83], v[64:79]
    v_mfma_f32_32x32x16_bf16 v[48:63], v[32:35], v[36:39], v[48:63]
    v_mfma_f32_32x32x16_bf16 v[64:79], v[32:35], v[80:83], v[64:79]
    v_mfma_f32_32x32x16_bf16 v[48:63], v[40:43], v[44:47], v[48:63]
    v_mfma_f32_32x32x16_bf16 v[64:79], v[40:43], v[80:83], v[64:79]
    s_cmp_eq_u32 s41, 11
    s_cbranch_scc1 GL_END
    s_cmp_ge_u32 s62, s41
    s_cbranch_scc1 GL_S2
    v_mov_b32 v86, 0x26500
LW_G2:
    ds_read_b64 v[84:85], v86 offset:0
    s_waitcnt lgkmcnt(0)
    v_min_u32 v84, v84, v85
    s_nop 0
    v_readfirstlane_b32 s62, v84
    s_cmp_lt_u32 s62, s41
    s_cbranch_scc1 LW_G2
GL_S2:
    ds_read_b64_tr_b16 v[16:17], v6 offset:0
    ds_read_b64_tr_b16 v[18:19], v6 offset:512
    ds_read_b128 v[20:23], v10
    ds_read_b64_tr_b16 v[24:25], v6 offset:2048
    ds_read_b64_tr_b16 v[26:27], v6 offset:2560
    ds_read_b128 v[28:31], v11
    ds_read_b64_tr_b16 v[32:33], v6 offset:4096
    ds_read_b64_tr_b16 v[34:35], v6 offset:4608
    ds_read_b128 v[36:39], v12
    ds_read_b64_tr_b16 v[40:41], v6 offset:6144
    ds_read_b64_tr_b16 v[42:43], v6 offset:6656
    ds_read_b128 v[44:47], v13
    s_movk_i32 s40, 0x2000
    s_cmp_eq_u32 s41, 9
    s_cselect_b32 s40, 4294918144, s40
    v_add_u32 v6, s40, v6
    v_add_u32 v10, s40, v10
    v_add_u32 v11, s40, v11
    v_add_u32 v12, s40, v12
    v_add_u32 v13, s40, v13
    s_add_u32 s41, s41, 1
    s_waitcnt lgkmcnt(12)
    v_mfma_f32_32x32x16_bf16 v[48:63], v[88:91], v[92:95], v[48:63]
    v_mfma_f32_32x32x16_bf16 v[64:79], v[88:91], v[80:83], v[64:79]
    v_mfma_f32_32x32x16_bf16 v[48:63], v[96:99], v[100:103], v[48:63]
    v_mfma_f32_32x32x16_bf16 v[64:79], v[96:99], v[80:83], v[64:79]
    v_mfma_f32_32x32x16_bf16 v[48:63], v[104:107], v[108:111], v[48:63]
    v_mfma_f32_32x32x16_bf16 v[64:79], v[104:107], v[80:83], v[64:79]
    v_mfma_f32_32x32x16_bf16 v[48:63], v[112:115], v[116:119], v[48:63]
    v_mfma_f32_32x32x16_bf16 v[64:79], v[112:115], v[80:83], v[64:79]
    s_branch GL_P1
GL_END:
    s_waitcnt lgkmcnt(0)
    v_mfma_f32_32x32x16_bf16 v[48:63], v[88:91], v[92:95], v[48:63]
    v_mfma_f32_32x32x16_bf16 v[64:79], v[88:91], v[80:83], v[64:79]
    v_mfma_f32_32x32x16_bf16 v[48:63], v[96:99], v[100:103], v[48:63]
    v_mfma_f32_32x32x16_bf16 v[64:79], v[96:99], v[80:83], v[64:79]
    v_mfma_f32_32x32x16_bf16 v[48:63], v[104:107], v[108:111], v[48:63]
    v_mfma_f32_32x32x16_bf16 v[64:79], v[104:107], v[80:83], v[64:79]
    v_mfma_f32_32x32x16_bf16 v[48:63], v[112:115], v[116:119], v[48:63]
    v_mfma_f32_32x32x16_bf16 v[64:79], v[112:115], v[80:83], v[64:79]
    v_mov_b32 v86, 0x26500
LW_TG:
    ds_read_b32 v84, v86 offset:20
    s_waitcnt lgkmcnt(0)
    v_readfirstlane_b32 s62, v84
    s_cmp_lt_u32 s62, 1
    s_cbranch_scc1 LW_TG
    s_mov_b32 s60, s62
    s_lshr_b32 s40, s16, 1
    s_lshl_b32 s40, s40, 5
    s_add_u32 s40, s40, s17
    s_lshl_b32 s40, s40, 4
    s_add_u32 s40, s40, 196608
    v_and_b32 v2, 31, v1
    v_lshlrev_b32 v2, 4, v2
    s_lshl_b32 s41, s16, 11
    s_add_u32 s41, s41, 114688
    v_lshlrev_b32 v5, 4, v1
    v_add_u32 v3, s41, v5
    s_mov_b32 s61, 0
POLL_ST:
    buffer_load_dwordx4 v[20:23], v2, s[24:27], s40 offen sc1
    s_add_u32 s61, s61, 1
    s_waitcnt vmcnt(0)
    v_cmp_ne_u32 vcc, s60, v22
    v_cmp_ne_u32 s[62:63], s60, v23
    s_or_b64 vcc, vcc, s[62:63]
    s_cmp_ge_u32 s61, 131072
    s_cbranch_scc1 POLLX_ST
    s_cmp_eq_u64 vcc, 0
    s_cbranch_scc1 POLLX_ST
    s_sleep 2
    s_branch POLL_ST
POLLX_ST:
    v_mov_b32 v86, 0x26500
LW_GQ:
    ds_read_b32 v84, v86 offset:16
    s_waitcnt lgkmcnt(0)
    v_readfirstlane_b32 s62, v84
    s_cmp_lt_u32 s62, 4
    s_cbranch_scc1 LW_GQ
    v_mul_f32 v6, 0x3eb8aa3b, v21
    v_mul_f32 v7, v20, v6
    v_mul_f32 v48, v48, v6
    v_mul_f32 v49, v49, v6
    v_mul_f32 v50, v50, v6
    v_mul_f32 v51, v51, v6
    v_mul_f32 v52, v52, v6
    v_mul_f32 v53, v53, v6
    v_mul_f32 v54, v54, v6
    v_mul_f32 v55, v55, v6
    v_mul_f32 v56, v56, v6
    v_mul_f32 v57, v57, v6
    v_mul_f32 v58, v58, v6
    v_mul_f32 v59, v59, v6
    v_mul_f32 v60, v60, v6
    v_mul_f32 v61, v61, v6
    v_mul_f32 v62, v62, v6
    v_mul_f32 v63, v63, v6
    v_fma_f32 v48, -v64, v7, v48
    v_fma_f32 v49, -v65, v7, v49
    v_fma_f32 v50, -v66, v7, v50
    v_fma_f32 v51, -v67, v7, v51
    v_fma_f32 v52, -v68, v7, v52
    v_fma_f32 v53, -v69, v7, v53
    v_fma_f32 v54, -v70, v7, v54
    v_fma_f32 v55, -v71, v7, v55
    v_fma_f32 v56, -v72, v7, v56
    v_fma_f32 v57, -v73, v7, v57
    v_fma_f32 v58, -v74, v7, v58
    v_fma_f32 v59, -v75, v7, v59
    v_fma_f32 v60, -v76, v7, v60
    v_fma_f32 v61, -v77, v7, v61
    v_fma_f32 v62, -v78, v7, v62
    v_fma_f32 v63, -v79, v7, v63
    v_cvt_pk_bf16_f32 v16, v48, v49
    v_cvt_pk_bf16_f32 v17, v50, v51
    v_cvt_pk_bf16_f32 v18, v52, v53
    v_cvt_pk_bf16_f32 v19, v54, v55
    v_cvt_pk_bf16_f32 v20, v56, v57
    v_cvt_pk_bf16_f32 v21, v58, v59
    v_cvt_pk_bf16_f32 v22, v60, v61
    v_cvt_pk_bf16_f32 v23, v62, v63
    ds_write_b128 v3, v[16:19]
    ds_write_b128 v3, v[20:23] offset:1024
    s_mov_b32 s46, 1
ATT:
    s_lshl_b32 s44, s16, 14
    s_lshl_b32 s45, s16, 15
    s_add_u32 s45, s45, 65536
    v_mov_b32 v8, 0xdddddddd
    v_mov_b64 v[32:33], 0
    v_mov_b64 v[34:35], 0
    v_mov_b64 v[36:37], 0
    v_mov_b64 v[38:39], 0
    v_mov_b64 v[40:41], 0
    v_mov_b64 v[42:43], 0
    v_mov_b64 v[44:45], 0
    v_mov_b64 v[46:47], 0
    v_mov_b64 v[48:49], 0
    v_mov_b64 v[50:51], 0
    v_mov_b64 v[52:53], 0
    v_mov_b64 v[54:55], 0
    v_mov_b64 v[56:57], 0
    v_mov_b64 v[58:59], 0
    v_mov_b64 v[60:61], 0
    v_mov_b64 v[62:63], 0
    v_mov_b64 v[64:65], 0
    v_mov_b64 v[66:67], 0
    v_mov_b64 v[68:69], 0
    v_mov_b64 v[70:71], 0
    v_mov_b64 v[72:73], 0
    v_mov_b64 v[74:75], 0
    v_mov_b64 v[76:77], 0
    v_mov_b64 v[78:79], 0
    v_mov_b64 v[80:81], 0
    v_mov_b64 v[82:83], 0
    v_mov_b64 v[84:85], 0
    v_mov_b64 v[86:87], 0
    v_mov_b64 v[88:89], 0
    v_mov_b64 v[90:91], 0
    v_mov_b64 v[92:93], 0
    v_mov_b64 v[94:95], 0
    v_mov_b64 v[148:149], 0
    v_mov_b64 v[150:151], 0
    v_mov_b64 v[120:121], 0
    v_mov_b64 v[122:123], 0
    v_mov_b64 v[124:125], 0
    v_mov_b64 v[126:127], 0
    s_lshl_b32 s40, s46, 12
    s_add_u32 s40, s40, 114688
    s_add_u32 s41, s16, 0
    s_and_b32 s41, s41, 3
    s_lshl_b32 s41, s41, 10
    s_add_u32 s41, s41, s40
    v_add_u32 v10, s41, v5
    s_add_u32 s41, s16, 1
    s_and_b32 s41, s41, 3
    s_lshl_b32 s41, s41, 10
    s_add_u32 s41, s41, s40
    v_add_u32 v11, s41, v5
    s_add_u32 s41, s16, 2
    s_and_b32 s41, s41, 3
    s_lshl_b32 s41, s41, 10
    s_add_u32 s41, s41, s40
    v_add_u32 v12, s41, v5
    s_add_u32 s41, s16, 3
    s_and_b32 s41, s41, 3
    s_lshl_b32 s41, s41, 10
    s_add_u32 s41, s41, s40
    v_add_u32 v13, s41, v5
    s_waitcnt lgkmcnt(0)
    s_barrier
    buffer_load_dwordx4 v[128:131], v5, s[24:27], s44 offen
    buffer_load_dwordx4 v[136:139], v5, s[24:27], s45 offen
    buffer_load_dwordx4 v[140:143], v5, s[24:27], s45 offen offset:1024
    buffer_load_dwordx4 v[132:135], v5, s[24:27], s44 offen offset:1024
    buffer_load_dwordx4 v[144:147], v5, s[24:27], s45 offen offset:2048
    s_add_u32 s44, s44, 2048
    s_add_u32 s45, s45, 3072
    ds_read_b128 v[16:19], v10
    ds_read_b128 v[20:23], v11
    ds_read_b128 v[24:27], v12
    ds_read_b128 v[28:31], v13
    s_waitcnt lgkmcnt(0)
    s_barrier
    s_waitcnt vmcnt(4)
    v_mfma_f32_32x32x16_bf16 v[96:111], v[128:131], v[16:19], 0
    s_mov_b32 s47, 0
    s_nop 15
.p2align 6
ATT_LOOP:
    v_exp_f32 v96, v96
    v_exp_f32 v97, v97
    v_smfmac_f32_32x32x32_bf16 v[80:95], v[148:151], v[120:127], v8
    buffer_load_dwordx4 v[148:151], v5, s[24:27], s45 offen
    s_add_u32 s45, s45, 1024
    v_exp_f32 v98, v98
    v_exp_f32 v99, v99
    v_exp_f32 v100, v100
    v_mfma_f32_32x32x16_bf16 v[112:127], v[128:131], v[20:23], 0
    v_exp_f32 v101, v101
    v_exp_f32 v102, v102
    v_exp_f32 v103, v103
    v_exp_f32 v104, v104
    v_exp_f32 v105, v105
    v_exp_f32 v106, v106
    v_exp_f32 v107, v107
    v_exp_f32 v108, v108
    v_exp_f32 v109, v109
    v_exp_f32 v110, v110
    s_waitcnt vmcnt(4)
    v_smfmac_f32_32x32x32_bf16 v[32:47], v[136:139], v[96:103], v8
    v_exp_f32 v111, v111
    v_exp_f32 v112, v112
    v_exp_f32 v113, v113
    s_waitcnt vmcnt(3)
    v_smfmac_f32_32x32x32_bf16 v[32:47], v[140:143], v[104:111], v8
    v_exp_f32 v114, v114
    v_exp_f32 v115, v115
    v_exp_f32 v116, v116
    v_mfma_f32_32x32x16_bf16 v[96:111], v[128:131], v[24:27], 0
    v_exp_f32 v117, v117
    v_exp_f32 v118, v118
    v_exp_f32 v119, v119
    v_exp_f32 v120, v120
    v_exp_f32 v121, v121
    v_exp_f32 v122, v122
    v_exp_f32 v123, v123
    v_exp_f32 v124, v124
    v_exp_f32 v125, v125
    v_exp_f32 v126, v126
    v_smfmac_f32_32x32x32_bf16 v[48:63], v[136:139], v[112:119], v8
    v_exp_f32 v127, v127
    v_exp_f32 v96, v96
    v_exp_f32 v97, v97
    v_smfmac_f32_32x32x32_bf16 v[48:63], v[140:143], v[120:127], v8
    v_exp_f32 v98, v98
    v_exp_f32 v99, v99
    v_exp_f32 v100, v100
    v_mfma_f32_32x32x16_bf16 v[112:127], v[128:131], v[28:31], 0
    buffer_load_dwordx4 v[128:131], v5, s[24:27], s44 offen
    s_add_u32 s44, s44, 1024
    v_exp_f32 v101, v101
    v_exp_f32 v102, v102
    v_exp_f32 v103, v103
    v_exp_f32 v104, v104
    v_exp_f32 v105, v105
    v_exp_f32 v106, v106
    v_exp_f32 v107, v107
    v_exp_f32 v108, v108
    v_exp_f32 v109, v109
    v_exp_f32 v110, v110
    v_smfmac_f32_32x32x32_bf16 v[64:79], v[136:139], v[96:103], v8
    v_exp_f32 v111, v111
    v_exp_f32 v112, v112
    v_exp_f32 v113, v113
    v_smfmac_f32_32x32x32_bf16 v[64:79], v[140:143], v[104:111], v8
    v_exp_f32 v114, v114
    v_exp_f32 v115, v115
    v_exp_f32 v116, v116
    s_waitcnt vmcnt(3)
    v_mfma_f32_32x32x16_bf16 v[96:111], v[132:135], v[16:19], 0
    v_exp_f32 v117, v117
    v_exp_f32 v118, v118
    v_exp_f32 v119, v119
    v_exp_f32 v120, v120
    v_exp_f32 v121, v121
    v_exp_f32 v122, v122
    v_exp_f32 v123, v123
    v_exp_f32 v124, v124
    v_exp_f32 v125, v125
    v_exp_f32 v126, v126
    v_smfmac_f32_32x32x32_bf16 v[80:95], v[136:139], v[112:119], v8
    buffer_load_dwordx4 v[136:139], v5, s[24:27], s45 offen
    s_add_u32 s45, s45, 1024
    v_exp_f32 v127, v127
    v_exp_f32 v96, v96
    v_exp_f32 v97, v97
    v_smfmac_f32_32x32x32_bf16 v[80:95], v[140:143], v[120:127], v8
    buffer_load_dwordx4 v[140:143], v5, s[24:27], s45 offen
    s_add_u32 s45, s45, 1024
    v_exp_f32 v98, v98
    v_exp_f32 v99, v99
    v_exp_f32 v100, v100
    v_mfma_f32_32x32x16_bf16 v[112:127], v[132:135], v[20:23], 0
    v_exp_f32 v101, v101
    v_exp_f32 v102, v102
    v_exp_f32 v103, v103
    v_exp_f32 v104, v104
    v_exp_f32 v105, v105
    v_exp_f32 v106, v106
    v_exp_f32 v107, v107
    v_exp_f32 v108, v108
    v_exp_f32 v109, v109
    v_exp_f32 v110, v110
    s_waitcnt vmcnt(4)
    v_smfmac_f32_32x32x32_bf16 v[32:47], v[144:147], v[96:103], v8
    v_exp_f32 v111, v111
    v_exp_f32 v112, v112
    v_exp_f32 v113, v113
    s_waitcnt vmcnt(3)
    v_smfmac_f32_32x32x32_bf16 v[32:47], v[148:151], v[104:111], v8
    v_exp_f32 v114, v114
    v_exp_f32 v115, v115
    v_exp_f32 v116, v116
    v_mfma_f32_32x32x16_bf16 v[96:111], v[132:135], v[24:27], 0
    v_exp_f32 v117, v117
    v_exp_f32 v118, v118
    v_exp_f32 v119, v119
    v_exp_f32 v120, v120
    v_exp_f32 v121, v121
    v_exp_f32 v122, v122
    v_exp_f32 v123, v123
    v_exp_f32 v124, v124
    v_exp_f32 v125, v125
    v_exp_f32 v126, v126
    v_smfmac_f32_32x32x32_bf16 v[48:63], v[144:147], v[112:119], v8
    v_exp_f32 v127, v127
    v_exp_f32 v96, v96
    v_exp_f32 v97, v97
    v_smfmac_f32_32x32x32_bf16 v[48:63], v[148:151], v[120:127], v8
    v_exp_f32 v98, v98
    v_exp_f32 v99, v99
    v_exp_f32 v100, v100
    v_mfma_f32_32x32x16_bf16 v[112:127], v[132:135], v[28:31], 0
    buffer_load_dwordx4 v[132:135], v5, s[24:27], s44 offen
    s_add_u32 s44, s44, 1024
    v_exp_f32 v101, v101
    v_exp_f32 v102, v102
    v_exp_f32 v103, v103
    v_exp_f32 v104, v104
    v_exp_f32 v105, v105
    v_exp_f32 v106, v106
    v_exp_f32 v107, v107
    v_exp_f32 v108, v108
    v_exp_f32 v109, v109
    v_exp_f32 v110, v110
    v_smfmac_f32_32x32x32_bf16 v[64:79], v[144:147], v[96:103], v8
    v_exp_f32 v111, v111
    v_exp_f32 v112, v112
    v_exp_f32 v113, v113
    v_smfmac_f32_32x32x32_bf16 v[64:79], v[148:151], v[104:111], v8
    v_exp_f32 v114, v114
    v_exp_f32 v115, v115
    v_exp_f32 v116, v116
    s_waitcnt vmcnt(3)
    v_mfma_f32_32x32x16_bf16 v[96:111], v[128:131], v[16:19], 0
    v_exp_f32 v117, v117
    v_exp_f32 v118, v118
    v_exp_f32 v119, v119
    v_exp_f32 v120, v120
    v_exp_f32 v121, v121
    v_exp_f32 v122, v122
    v_exp_f32 v123, v123
    v_exp_f32 v124, v124
    v_exp_f32 v125, v125
    v_exp_f32 v126, v126
    v_smfmac_f32_32x32x32_bf16 v[80:95], v[144:147], v[112:119], v8
    buffer_load_dwordx4 v[144:147], v5, s[24:27], s45 offen
    s_add_u32 s45, s45, 1024
    v_exp_f32 v127, v127
    s_add_u32 s47, s47, 1
    s_cmp_lt_u32 s47, 8
    s_cbranch_scc1 ATT_LOOP
    s_nop 1
    v_smfmac_f32_32x32x32_bf16 v[80:95], v[148:151], v[120:127], v8
    s_mul_i32 s40, s46, 27648
    v_lshlrev_b32 v9, 2, v1
    s_add_u32 s41, s16, 1
    s_and_b32 s41, s41, 3
    s_mul_i32 s41, s41, 6912
    s_add_u32 s41, s41, s40
    v_add_u32 v10, s41, v5
    v_add_u32 v13, s41, v9
    s_add_u32 s41, s16, 2
    s_and_b32 s41, s41, 3
    s_mul_i32 s41, s41, 6912
    s_add_u32 s41, s41, s40
    v_add_u32 v11, s41, v5
    v_add_u32 v14, s41, v9
    s_add_u32 s41, s16, 3
    s_and_b32 s41, s41, 3
    s_mul_i32 s41, s41, 6912
    s_add_u32 s41, s41, s40
    v_add_u32 v12, s41, v5
    v_add_u32 v15, s41, v9
    s_mul_i32 s41, s16, 6912
    s_add_u32 s41, s41, s40
    v_add_u32 v6, s41, v5
    v_add_u32 v7, s41, v9
    ds_write_b128 v10, v[48:51] offset:0
    ds_write_b128 v10, v[52:55] offset:1024
    ds_write_b32 v13, v56 offset:2048
    ds_write_b128 v11, v[64:67] offset:2304
    ds_write_b128 v11, v[68:71] offset:3328
    ds_write_b32 v14, v72 offset:4352
    ds_write_b128 v12, v[80:83] offset:4608
    ds_write_b128 v12, v[84:87] offset:5632
    ds_write_b32 v15, v88 offset:6656
    s_add_u32 s32, s14, 0x200000
    s_addc_u32 s33, s15, 0
    s_mov_b32 s34, 0x200000
    s_mov_b32 s35, 0x00020000
    s_mov_b32 s67, 0
    s_waitcnt lgkmcnt(0)
    s_cmp_eq_u32 s46, 1
    s_cbranch_scc1 ATT_BR
    v_mov_b32 v2, 0xf800
SELW:
    ds_read_b128 v[48:51], v2
    s_waitcnt vmcnt(0) lgkmcnt(0)
    v_readfirstlane_b32 s40, v48
    v_readfirstlane_b32 s76, v49
    v_readfirstlane_b32 s77, v50
    s_cmp_eq_u32 s40, 0
    s_cbranch_scc1 SELW
    s_and_b32 s59, s76, 0xffff
    s_sub_u32 s59, 2047, s59
    s_sub_u32 s59, s59, s64
    s_cmp_lt_u32 s59, 32
    s_cbranch_scc1 ATT_ROUTED
    s_and_b32 s59, s77, 0xffff
    s_sub_u32 s59, 2047, s59
    s_sub_u32 s59, s59, s64
    s_cmp_lt_u32 s59, 32
    s_cbranch_scc1 ATT_ROUTED
    s_waitcnt lgkmcnt(0)
ATT_BR:
    s_barrier
    ds_read_b128 v[48:51], v6 offset:0
    ds_read_b128 v[52:55], v6 offset:1024
    ds_read_b32 v56, v7 offset:2048
    ds_read_b128 v[64:67], v6 offset:2304
    ds_read_b128 v[68:71], v6 offset:3328
    ds_read_b32 v72, v7 offset:4352
    ds_read_b128 v[80:83], v6 offset:4608
    ds_read_b128 v[84:87], v6 offset:5632
    ds_read_b32 v88, v7 offset:6656
    v_mov_b32 v2, 0xf800
    ds_read_b32 v9, v2 offset:12
    s_mov_b32 s48, 0x7f000000
    s_mov_b32 s49, 0x1f800000
    s_mov_b32 s50, 0x5f800000
    v_and_b32 v2, 31, v1
    v_lshrrev_b32 v3, 5, v1
    v_mul_u32_u24 v4, 144, v2
    v_lshl_add_u32 v4, v3, 4, v4
    s_mul_i32 s40, s46, 4608
    s_lshl_b32 s41, s16, 5
    s_add_u32 s40, s40, s41
    s_add_u32 s40, s40, 131072
    v_add_u32 v4, s40, v4
    v_lshrrev_b32 v2, 3, v1
    v_and_b32 v3, 7, v1
    v_mul_u32_u24 v15, 144, v2
    v_lshl_add_u32 v15, v3, 4, v15
    s_mul_i32 s40, s78, 1152
    s_add_u32 s40, s40, 126464
    v_add_u32 v15, s40, v15
    v_mov_b32 v2, v5
    s_lshl_b32 s40, s78, 10
    s_lshl_b32 s41, s17, 10
    s_add_u32 s40, s40, s41
    s_lshl_b32 s41, s19, 13
    s_add_u32 s40, s40, s41
    s_sub_u32 s51, s40, 4096
    s_waitcnt lgkmcnt(7)
    v_pk_add_f32 v[32:33], v[32:33], v[48:49]
    v_pk_add_f32 v[34:35], v[34:35], v[50:51]
    v_pk_add_f32 v[36:37], v[36:37], v[52:53]
    v_pk_add_f32 v[38:39], v[38:39], v[54:55]
    v_add_f32 v40, v40, v56
    s_waitcnt lgkmcnt(4)
    v_pk_add_f32 v[32:33], v[32:33], v[64:65]
    v_pk_add_f32 v[34:35], v[34:35], v[66:67]
    v_pk_add_f32 v[36:37], v[36:37], v[68:69]
    v_pk_add_f32 v[38:39], v[38:39], v[70:71]
    v_add_f32 v40, v40, v72
    s_waitcnt lgkmcnt(1)
    v_pk_add_f32 v[32:33], v[32:33], v[80:81]
    v_pk_add_f32 v[34:35], v[34:35], v[82:83]
    v_pk_add_f32 v[36:37], v[36:37], v[84:85]
    v_pk_add_f32 v[38:39], v[38:39], v[86:87]
    v_add_f32 v40, v40, v88
    s_waitcnt lgkmcnt(0)
    v_readfirstlane_b32 s57, v9
    v_add_f32 v11, abs(v32), abs(v33)
    v_add_f32 v12, abs(v34), abs(v35)
    v_add_f32 v13, abs(v36), abs(v37)
    v_add_f32 v14, abs(v38), abs(v39)
    v_add_f32 v11, v11, v12
    v_add_f32 v13, v13, v14
    v_add_f32 v11, v11, v13
    v_cmp_gt_f32 s[52:53], s48, v11
    v_cmp_le_f32 s[54:55], s49, v40
    v_cmp_ge_f32 vcc, s50, v40
    s_and_b64 s[52:53], s[52:53], s[54:55]
    s_and_b64 s[52:53], s[52:53], vcc
    s_cmp_eq_u64 s[52:53], -1
    s_cbranch_scc0 ATT_SLOW
ATT_FIN:
    v_rcp_f32 v11, v40
    s_nop 0
    v_mul_f32 v32, v32, v11
    v_mul_f32 v33, v33, v11
    v_mul_f32 v34, v34, v11
    v_mul_f32 v35, v35, v11
    v_mul_f32 v36, v36, v11
    v_mul_f32 v37, v37, v11
    v_mul_f32 v38, v38, v11
    v_mul_f32 v39, v39, v11
    v_cvt_pk_bf16_f32 v44, v32, v33
    v_cvt_pk_bf16_f32 v45, v34, v35
    v_cvt_pk_bf16_f32 v46, v36, v37
    v_cvt_pk_bf16_f32 v47, v38, v39
    ds_write_b128 v4, v[44:47]
    s_waitcnt lgkmcnt(0)
    s_barrier
    ds_read_b128 v[44:47], v15
    s_waitcnt lgkmcnt(0)
    s_cmp_eq_u32 s57, 1
    s_cbranch_scc1 ATT_ST1
    buffer_store_dwordx4 v[44:47], v2, s[32:35], s51 offen sc1
    s_branch ATT_ST2
ATT_ST1:
    buffer_store_dwordx4 v[44:47], v2, s[32:35], s51 offen
ATT_ST2:
    v_mov_b32 v4, 0x23000
    v_mov_b32 v3, 1
    s_lshl_b32 s40, s17, 4
    s_lshl_b32 s41, s19, 7
    s_add_u32 s40, s40, s41
    s_add_u32 s40, s40, 294912
    v_mov_b32 v9, s60
    v_mov_b32 v10, 0
    s_waitcnt vmcnt(0)
    s_mov_b64 exec, 1
    ds_add_rtn_u32 v3, v4, v3 offset:32
    s_waitcnt lgkmcnt(0)
    v_readfirstlane_b32 s41, v3
    s_cmp_lg_u32 s41, 7
    s_cbranch_scc1 ATT_NOFLAG
    s_cmp_eq_u32 s57, 1
    s_cbranch_scc1 ATT_FL1
    buffer_store_dword v9, v10, s[24:27], s40 offen sc1
    s_branch ATT_NOFLAG
ATT_FL1:
    buffer_store_dword v9, v10, s[24:27], s40 offen
ATT_NOFLAG:
    s_mov_b64 exec, -1
    s_cmp_eq_u32 s46, 0
    s_cbranch_scc1 P3
    s_branch P3LOAD
L_END:
    s_endpgm
ATT_SLOW:
    s_mov_b32 s67, 1
    v_mov_b32 v11, 0xff7fffff
    s_mov_b32 s44, 0
ATT_SLOW1:
    buffer_load_dwordx4 v[128:131], v5, s[24:27], s44 offen
    s_waitcnt vmcnt(0)
    v_mfma_f32_32x32x16_bf16 v[96:111], v[128:131], v[16:19], 0
    s_nop 15
    s_nop 3
    v_max3_f32 v11, v96, v97, v11
    v_max3_f32 v11, v98, v99, v11
    v_max3_f32 v11, v100, v101, v11
    v_max3_f32 v11, v102, v103, v11
    v_max3_f32 v11, v104, v105, v11
    v_max3_f32 v11, v106, v107, v11
    v_max3_f32 v11, v108, v109, v11
    v_max3_f32 v11, v110, v111, v11
    s_add_u32 s44, s44, 1024
    s_cmp_lt_u32 s44, 0x10000
    s_cbranch_scc1 ATT_SLOW1
    v_mov_b32 v9, v11
    s_nop 1
    v_permlane32_swap_b32 v11, v9
    s_nop 1
    v_max_f32 v11, v11, v9
    v_sub_f32 v112, 0, v11
    v_sub_f32 v113, 0, v11
    v_sub_f32 v114, 0, v11
    v_sub_f32 v115, 0, v11
    v_sub_f32 v116, 0, v11
    v_sub_f32 v117, 0, v11
    v_sub_f32 v118, 0, v11
    v_sub_f32 v119, 0, v11
    v_sub_f32 v120, 0, v11
    v_sub_f32 v121, 0, v11
    v_sub_f32 v122, 0, v11
    v_sub_f32 v123, 0, v11
    v_sub_f32 v124, 0, v11
    v_sub_f32 v125, 0, v11
    v_sub_f32 v126, 0, v11
    v_sub_f32 v127, 0, v11
    v_mov_b64 v[32:33], 0
    v_mov_b64 v[34:35], 0
    v_mov_b64 v[36:37], 0
    v_mov_b64 v[38:39], 0
    v_mov_b64 v[40:41], 0
    v_mov_b64 v[42:43], 0
    v_mov_b64 v[44:45], 0
    v_mov_b64 v[46:47], 0
    s_mov_b32 s44, 0
    s_mov_b32 s45, 65536
ATT_SLOW2:
    buffer_load_dwordx4 v[128:131], v5, s[24:27], s44 offen
    buffer_load_dwordx4 v[136:139], v5, s[24:27], s45 offen
    buffer_load_dwordx4 v[140:143], v5, s[24:27], s45 offen offset:1024
    s_waitcnt vmcnt(0)
    v_mfma_f32_32x32x16_bf16 v[96:111], v[128:131], v[16:19], v[112:127]
    s_nop 15
    s_nop 3
    v_exp_f32 v96, v96
    v_exp_f32 v97, v97
    v_exp_f32 v98, v98
    v_exp_f32 v99, v99
    v_exp_f32 v100, v100
    v_exp_f32 v101, v101
    v_exp_f32 v102, v102
    v_exp_f32 v103, v103
    v_exp_f32 v104, v104
    v_exp_f32 v105, v105
    v_exp_f32 v106, v106
    v_exp_f32 v107, v107
    v_exp_f32 v108, v108
    v_exp_f32 v109, v109
    v_exp_f32 v110, v110
    v_exp_f32 v111, v111
    s_nop 1
    v_smfmac_f32_32x32x32_bf16 v[32:47], v[136:139], v[96:103], v8
    v_smfmac_f32_32x32x32_bf16 v[32:47], v[140:143], v[104:111], v8
    s_nop 15
    s_nop 3
    s_add_u32 s44, s44, 1024
    s_add_u32 s45, s45, 2048
    s_cmp_lt_u32 s44, 0x10000
    s_cbranch_scc1 ATT_SLOW2
    s_branch ATT_FIN
P3:
    s_mov_b32 s70, 0x200000
    s_mov_b32 s71, 0x00020000
    v_lshrrev_b32 v144, 2, v1
    v_and_b32 v145, 3, v1
    v_lshlrev_b32 v146, 10, v144
    v_lshl_add_u32 v146, v145, 4, v146
    v_lshlrev_b32 v96, 16, v152
    v_and_b32 v97, s42, v152
    v_lshlrev_b32 v112, 16, v160
    v_and_b32 v113, s42, v160
    v_lshlrev_b32 v98, 16, v153
    v_and_b32 v99, s42, v153
    v_lshlrev_b32 v114, 16, v161
    v_and_b32 v115, s42, v161
    v_lshlrev_b32 v100, 16, v154
    v_and_b32 v101, s42, v154
    v_lshlrev_b32 v116, 16, v162
    v_and_b32 v117, s42, v162
    v_lshlrev_b32 v102, 16, v155
    v_and_b32 v103, s42, v155
    v_lshlrev_b32 v118, 16, v163
    v_and_b32 v119, s42, v163
    v_lshlrev_b32 v104, 16, v156
    v_and_b32 v105, s42, v156
    v_lshlrev_b32 v120, 16, v164
    v_and_b32 v121, s42, v164
    v_lshlrev_b32 v106, 16, v157
    v_and_b32 v107, s42, v157
    v_lshlrev_b32 v122, 16, v165
    v_and_b32 v123, s42, v165
    v_lshlrev_b32 v108, 16, v158
    v_and_b32 v109, s42, v158
    v_lshlrev_b32 v124, 16, v166
    v_and_b32 v125, s42, v166
    v_lshlrev_b32 v110, 16, v159
    v_and_b32 v111, s42, v159
    v_lshlrev_b32 v126, 16, v167
    v_and_b32 v127, s42, v167
    v_lshrrev_b32 v3, 5, v1
    v_lshrrev_b32 v5, 2, v1
    v_and_b32 v5, 3, v5
    v_lshl_add_u32 v6, v3, 3, v5
    v_lshlrev_b32 v6, 7, v6
    v_lshrrev_b32 v7, 1, v5
    s_and_b32 s40, s16, 1
    v_xor_b32 v7, s40, v7
    v_lshl_add_u32 v6, v7, 6, v6
    v_and_b32 v7, 16, v1
    v_lshl_add_u32 v6, v7, 1, v6
    v_and_b32 v7, 1, v1
    v_lshl_add_u32 v6, v7, 4, v6
    v_and_b32 v7, 2, v1
    v_lshl_add_u32 v6, v7, 2, v6
    v_add_u32 v6, 0x10000, v6
    v_and_b32 v2, 31, v1
    v_lshrrev_b32 v5, 1, v2
    v_and_b32 v5, 7, v5
    v_xor_b32 v5, v5, v3
    v_lshlrev_b32 v2, 7, v2
    v_lshl_add_u32 v2, v5, 4, v2
    s_lshr_b32 s40, s16, 1
    s_lshl_b32 s40, s40, 12
    v_add_u32 v10, s40, v2
    v_xor_b32 v11, 32, v10
    v_xor_b32 v12, 64, v10
    v_xor_b32 v13, 96, v10
    s_mul_i32 s40, s16, 4352
    s_add_u32 s40, s40, 144384
    v_lshlrev_b32 v14, 4, v1
    v_add_u32 v14, s40, v14
    v_lshrrev_b32 v15, 1, v145
    v_mul_u32_u24 v15, 2176, v15
    v_and_b32 v2, 1, v145
    v_lshl_add_u32 v15, v2, 9, v15
    v_lshl_add_u32 v15, v144, 4, v15
    v_add_u32 v15, s40, v15
    v_mov_b64 v[48:49], 0
    v_mov_b64 v[50:51], 0
    v_mov_b64 v[52:53], 0
    v_mov_b64 v[54:55], 0
    v_mov_b64 v[56:57], 0
    v_mov_b64 v[58:59], 0
    v_mov_b64 v[60:61], 0
    v_mov_b64 v[62:63], 0
    s_mov_b32 s41, 0
    v_mov_b32 v4, 0x23000
P3_LOOP:
    ds_read_b32 v2, v4 offset:16
    s_waitcnt lgkmcnt(0)
    v_readfirstlane_b32 s40, v2
    s_andn2_b32 s40, s40, s41
    s_cbranch_scc0 P3_LOOP
P3_CH:
    s_ff1_i32_b32 s43, s40
    s_bitset1_b32 s41, s43
    s_bitset0_b32 s40, s43
    s_lshl_b32 s43, s43, 13
    v_add_u32 v128, s43, v6
    v_add_u32 v129, s43, v10
    v_add_u32 v130, s43, v11
    v_add_u32 v131, s43, v12
    v_add_u32 v132, s43, v13
    ds_read_b64_tr_b16 v[16:17], v128 offset:0
    ds_read_b64_tr_b16 v[18:19], v128 offset:512
    ds_read_b128 v[20:23], v129
    ds_read_b64_tr_b16 v[24:25], v128 offset:2048
    ds_read_b64_tr_b16 v[26:27], v128 offset:2560
    ds_read_b128 v[28:31], v130
    ds_read_b64_tr_b16 v[32:33], v128 offset:4096
    ds_read_b64_tr_b16 v[34:35], v128 offset:4608
    ds_read_b128 v[36:39], v131
    ds_read_b64_tr_b16 v[40:41], v128 offset:6144
    ds_read_b64_tr_b16 v[42:43], v128 offset:6656
    ds_read_b128 v[44:47], v132
    s_cmp_eq_u32 s40, 0
    s_cbranch_scc1 P3_ONE
    s_ff1_i32_b32 s43, s40
    s_bitset1_b32 s41, s43
    s_bitset0_b32 s40, s43
    s_lshl_b32 s43, s43, 13
    v_add_u32 v134, s43, v6
    v_add_u32 v135, s43, v10
    v_add_u32 v136, s43, v11
    v_add_u32 v137, s43, v12
    v_add_u32 v138, s43, v13
    s_waitcnt lgkmcnt(3)
    ds_read_b64_tr_b16 v[64:65], v134 offset:0
    ds_read_b64_tr_b16 v[66:67], v134 offset:512
    ds_read_b128 v[68:71], v135
    ds_read_b64_tr_b16 v[72:73], v134 offset:2048
    ds_read_b64_tr_b16 v[74:75], v134 offset:2560
    ds_read_b128 v[76:79], v136
    ds_read_b64_tr_b16 v[80:81], v134 offset:4096
    ds_read_b64_tr_b16 v[82:83], v134 offset:4608
    ds_read_b128 v[84:87], v137
    ds_read_b64_tr_b16 v[88:89], v134 offset:6144
    ds_read_b64_tr_b16 v[90:91], v134 offset:6656
    ds_read_b128 v[92:95], v138
    s_waitcnt lgkmcnt(12)
    v_mfma_f32_32x32x16_bf16 v[48:63], v[16:19], v[20:23], v[48:63]
    v_mfma_f32_32x32x16_bf16 v[48:63], v[24:27], v[28:31], v[48:63]
    v_mfma_f32_32x32x16_bf16 v[48:63], v[32:35], v[36:39], v[48:63]
    v_mfma_f32_32x32x16_bf16 v[48:63], v[40:43], v[44:47], v[48:63]
    s_waitcnt lgkmcnt(9)
    v_mfma_f32_32x32x16_bf16 v[48:63], v[64:67], v[68:71], v[48:63]
    s_waitcnt lgkmcnt(6)
    v_mfma_f32_32x32x16_bf16 v[48:63], v[72:75], v[76:79], v[48:63]
    s_waitcnt lgkmcnt(3)
    v_mfma_f32_32x32x16_bf16 v[48:63], v[80:83], v[84:87], v[48:63]
    s_waitcnt lgkmcnt(0)
    v_mfma_f32_32x32x16_bf16 v[48:63], v[88:91], v[92:95], v[48:63]
    s_branch P3_NXT
P3_ONE:
    s_waitcnt lgkmcnt(9)
    v_mfma_f32_32x32x16_bf16 v[48:63], v[16:19], v[20:23], v[48:63]
    s_waitcnt lgkmcnt(6)
    v_mfma_f32_32x32x16_bf16 v[48:63], v[24:27], v[28:31], v[48:63]
    s_waitcnt lgkmcnt(3)
    v_mfma_f32_32x32x16_bf16 v[48:63], v[32:35], v[36:39], v[48:63]
    s_waitcnt lgkmcnt(0)
    v_mfma_f32_32x32x16_bf16 v[48:63], v[40:43], v[44:47], v[48:63]
P3_NXT:
    s_cmp_lg_u32 s40, 0
    s_cbranch_scc1 P3_CH
    s_cmp_lg_u32 s41, 0xff
    s_cbranch_scc1 P3_LOOP
    s_nop 15
    ds_write_b128 v14, v[48:51] offset:0
    ds_write_b128 v14, v[52:55] offset:1088
    ds_write_b128 v14, v[56:59] offset:2176
    ds_write_b128 v14, v[60:63] offset:3264
    s_waitcnt lgkmcnt(0)
    ds_read_b128 v[16:19], v15 offset:0
    ds_read_b128 v[20:23], v15 offset:1088
    ds_read_b128 v[24:27], v15 offset:256
    ds_read_b128 v[28:31], v15 offset:1344
    s_waitcnt lgkmcnt(0)
    v_pk_fma_f32 v[16:17], v[16:17], v[96:97], v[112:113]
    v_pk_fma_f32 v[18:19], v[18:19], v[98:99], v[114:115]
    v_pk_fma_f32 v[20:21], v[20:21], v[100:101], v[116:117]
    v_pk_fma_f32 v[22:23], v[22:23], v[102:103], v[118:119]
    v_pk_fma_f32 v[24:25], v[24:25], v[104:105], v[120:121]
    v_pk_fma_f32 v[26:27], v[26:27], v[106:107], v[122:123]
    v_pk_fma_f32 v[28:29], v[28:29], v[108:109], v[124:125]
    v_pk_fma_f32 v[30:31], v[30:31], v[110:111], v[126:127]
    v_cvt_pk_bf16_f32 v64, v16, v17
    v_cvt_pk_bf16_f32 v65, v18, v19
    v_cvt_pk_bf16_f32 v66, v20, v21
    v_cvt_pk_bf16_f32 v67, v22, v23
    v_cvt_pk_bf16_f32 v68, v24, v25
    v_cvt_pk_bf16_f32 v69, v26, v27
    v_cvt_pk_bf16_f32 v70, v28, v29
    v_cvt_pk_bf16_f32 v71, v30, v31
    buffer_store_dwordx4 v[64:67], v146, s[68:71], s65 offen
    buffer_store_dwordx4 v[68:71], v146, s[68:71], s66 offen
    s_endpgm
ATT_ROUTED:
    v_lshrrev_b32 v144, 2, v1
    v_and_b32 v145, 3, v1
    v_lshlrev_b32 v146, 10, v144
    v_lshl_add_u32 v146, v145, 4, v146
    buffer_load_dwordx4 v[128:131], v146, s[20:23], s65 offen
    buffer_load_dwordx4 v[132:135], v146, s[20:23], s66 offen
    v_lshlrev_b32 v48, 4, v144
    s_lshl_b32 s40, s64, 4
    s_add_u32 s40, s40, 196608
    buffer_load_dwordx2 v[148:149], v48, s[24:27], s40 offen sc1
    buffer_load_dwordx2 v[150:151], v48, s[24:27], s40 offen offset:256 sc1
    s_waitcnt vmcnt(0)
    v_lshlrev_b32 v112, 16, v128
    v_and_b32 v113, s42, v128
    v_lshlrev_b32 v114, 16, v129
    v_and_b32 v115, s42, v129
    v_lshlrev_b32 v116, 16, v130
    v_and_b32 v117, s42, v130
    v_lshlrev_b32 v118, 16, v131
    v_and_b32 v119, s42, v131
    v_lshlrev_b32 v120, 16, v132
    v_and_b32 v121, s42, v132
    v_lshlrev_b32 v122, 16, v133
    v_and_b32 v123, s42, v133
    v_lshlrev_b32 v124, 16, v134
    v_and_b32 v125, s42, v134
    v_lshlrev_b32 v126, 16, v135
    v_and_b32 v127, s42, v135
    v_sub_f32 v136, 0, v148
    v_sub_f32 v137, 0, v148
    v_mov_b32 v138, v149
    v_mov_b32 v139, v149
    v_sub_f32 v140, 0, v150
    v_sub_f32 v141, 0, v150
    v_mov_b32 v142, v151
    v_mov_b32 v143, v151
    v_pk_add_f32 v[96:97], v[112:113], v[136:137]
    v_pk_add_f32 v[98:99], v[114:115], v[136:137]
    v_pk_add_f32 v[100:101], v[116:117], v[136:137]
    v_pk_add_f32 v[102:103], v[118:119], v[136:137]
    v_pk_add_f32 v[104:105], v[120:121], v[140:141]
    v_pk_add_f32 v[106:107], v[122:123], v[140:141]
    v_pk_add_f32 v[108:109], v[124:125], v[140:141]
    v_pk_add_f32 v[110:111], v[126:127], v[140:141]
    v_cvt_pk_bf16_f32 v128, v96, v97
    v_cvt_pk_bf16_f32 v129, v98, v99
    v_cvt_pk_bf16_f32 v130, v100, v101
    v_cvt_pk_bf16_f32 v131, v102, v103
    v_cvt_pk_bf16_f32 v132, v104, v105
    v_cvt_pk_bf16_f32 v133, v106, v107
    v_cvt_pk_bf16_f32 v134, v108, v109
    v_cvt_pk_bf16_f32 v135, v110, v111
    v_lshlrev_b32 v96, 16, v128
    v_and_b32 v97, s42, v128
    v_lshlrev_b32 v98, 16, v129
    v_and_b32 v99, s42, v129
    v_lshlrev_b32 v100, 16, v130
    v_and_b32 v101, s42, v130
    v_lshlrev_b32 v102, 16, v131
    v_and_b32 v103, s42, v131
    v_lshlrev_b32 v104, 16, v132
    v_and_b32 v105, s42, v132
    v_lshlrev_b32 v106, 16, v133
    v_and_b32 v107, s42, v133
    v_lshlrev_b32 v108, 16, v134
    v_and_b32 v109, s42, v134
    v_lshlrev_b32 v110, 16, v135
    v_and_b32 v111, s42, v135
    v_pk_mul_f32 v[96:97], v[96:97], v[138:139]
    v_pk_mul_f32 v[98:99], v[98:99], v[138:139]
    v_pk_mul_f32 v[100:101], v[100:101], v[138:139]
    v_pk_mul_f32 v[102:103], v[102:103], v[138:139]
    v_pk_mul_f32 v[104:105], v[104:105], v[142:143]
    v_pk_mul_f32 v[106:107], v[106:107], v[142:143]
    v_pk_mul_f32 v[108:109], v[108:109], v[142:143]
    v_pk_mul_f32 v[110:111], v[110:111], v[142:143]
    v_cvt_pk_bf16_f32 v128, v96, v97
    v_cvt_pk_bf16_f32 v129, v98, v99
    v_cvt_pk_bf16_f32 v130, v100, v101
    v_cvt_pk_bf16_f32 v131, v102, v103
    v_cvt_pk_bf16_f32 v132, v104, v105
    v_cvt_pk_bf16_f32 v133, v106, v107
    v_cvt_pk_bf16_f32 v134, v108, v109
    v_cvt_pk_bf16_f32 v135, v110, v111
    v_lshlrev_b32 v96, 16, v128
    v_and_b32 v97, s42, v128
    v_lshlrev_b32 v98, 16, v129
    v_and_b32 v99, s42, v129
    v_lshlrev_b32 v100, 16, v130
    v_and_b32 v101, s42, v130
    v_lshlrev_b32 v102, 16, v131
    v_and_b32 v103, s42, v131
    v_lshlrev_b32 v104, 16, v132
    v_and_b32 v105, s42, v132
    v_lshlrev_b32 v106, 16, v133
    v_and_b32 v107, s42, v133
    v_lshlrev_b32 v108, 16, v134
    v_and_b32 v109, s42, v134
    v_lshlrev_b32 v110, 16, v135
    v_and_b32 v111, s42, v135
    s_mov_b32 s58, s76
    s_mov_b32 s47, 0
PU_A:
    s_and_b32 s59, s58, 0xffff
    s_sub_u32 s59, 2047, s59
    s_sub_u32 s59, s59, s64
    s_cmp_lt_u32 s59, 32
    s_cbranch_scc1 PUY_A
PUN_A:
    s_mov_b32 s58, s77
    s_add_u32 s47, s47, 2048
    s_cmp_lt_u32 s47, 4096
    s_cbranch_scc1 PU_A
    v_mul_f32 v48, 0xbfb8aa3b, v96
    v_mul_f32 v49, 0xbfb8aa3b, v97
    v_mul_f32 v50, 0xbfb8aa3b, v98
    v_mul_f32 v51, 0xbfb8aa3b, v99
    v_mul_f32 v52, 0xbfb8aa3b, v100
    v_mul_f32 v53, 0xbfb8aa3b, v101
    v_mul_f32 v54, 0xbfb8aa3b, v102
    v_mul_f32 v55, 0xbfb8aa3b, v103
    v_mul_f32 v56, 0xbfb8aa3b, v104
    v_mul_f32 v57, 0xbfb8aa3b, v105
    v_mul_f32 v58, 0xbfb8aa3b, v106
    v_mul_f32 v59, 0xbfb8aa3b, v107
    v_mul_f32 v60, 0xbfb8aa3b, v108
    v_mul_f32 v61, 0xbfb8aa3b, v109
    v_mul_f32 v62, 0xbfb8aa3b, v110
    v_mul_f32 v63, 0xbfb8aa3b, v111
    v_exp_f32 v48, v48
    v_exp_f32 v49, v49
    v_exp_f32 v50, v50
    v_exp_f32 v51, v51
    v_exp_f32 v52, v52
    v_exp_f32 v53, v53
    v_exp_f32 v54, v54
    v_exp_f32 v55, v55
    v_exp_f32 v56, v56
    v_exp_f32 v57, v57
    v_exp_f32 v58, v58
    v_exp_f32 v59, v59
    v_exp_f32 v60, v60
    v_exp_f32 v61, v61
    v_exp_f32 v62, v62
    v_exp_f32 v63, v63
    v_add_f32 v48, 1.0, v48
    v_add_f32 v49, 1.0, v49
    v_add_f32 v50, 1.0, v50
    v_add_f32 v51, 1.0, v51
    v_add_f32 v52, 1.0, v52
    v_add_f32 v53, 1.0, v53
    v_add_f32 v54, 1.0, v54
    v_add_f32 v55, 1.0, v55
    v_add_f32 v56, 1.0, v56
    v_add_f32 v57, 1.0, v57
    v_add_f32 v58, 1.0, v58
    v_add_f32 v59, 1.0, v59
    v_add_f32 v60, 1.0, v60
    v_add_f32 v61, 1.0, v61
    v_add_f32 v62, 1.0, v62
    v_add_f32 v63, 1.0, v63
    v_rcp_f32 v48, v48
    v_rcp_f32 v49, v49
    v_rcp_f32 v50, v50
    v_rcp_f32 v51, v51
    v_rcp_f32 v52, v52
    v_rcp_f32 v53, v53
    v_rcp_f32 v54, v54
    v_rcp_f32 v55, v55
    v_rcp_f32 v56, v56
    v_rcp_f32 v57, v57
    v_rcp_f32 v58, v58
    v_rcp_f32 v59, v59
    v_rcp_f32 v60, v60
    v_rcp_f32 v61, v61
    v_rcp_f32 v62, v62
    v_rcp_f32 v63, v63
    v_pk_mul_f32 v[96:97], v[96:97], v[48:49]
    v_pk_mul_f32 v[98:99], v[98:99], v[50:51]
    v_pk_mul_f32 v[100:101], v[100:101], v[52:53]
    v_pk_mul_f32 v[102:103], v[102:103], v[54:55]
    v_pk_mul_f32 v[104:105], v[104:105], v[56:57]
    v_pk_mul_f32 v[106:107], v[106:107], v[58:59]
    v_pk_mul_f32 v[108:109], v[108:109], v[60:61]
    v_pk_mul_f32 v[110:111], v[110:111], v[62:63]
    v_cvt_pk_bf16_f32 v152, v96, v97
    v_cvt_pk_bf16_f32 v153, v98, v99
    v_cvt_pk_bf16_f32 v154, v100, v101
    v_cvt_pk_bf16_f32 v155, v102, v103
    v_cvt_pk_bf16_f32 v156, v104, v105
    v_cvt_pk_bf16_f32 v157, v106, v107
    v_cvt_pk_bf16_f32 v158, v108, v109
    v_cvt_pk_bf16_f32 v159, v110, v111
    s_branch ATT_BR
PUY_A:
    v_min_u32 v136, 55, v1
    v_lshlrev_b32 v136, 7, v136
    s_mov_b32 s44, 327680
    s_mov_b32 s45, 334848
    s_mov_b32 s61, 0
POLL_FFA:
    buffer_load_dword v128, v136, s[24:27], s44 offen sc1
    buffer_load_dword v129, v136, s[24:27], s45 offen sc1
    s_add_u32 s61, s61, 1
    s_waitcnt vmcnt(0)
    v_cmp_ne_u32 vcc, s60, v128
    v_cmp_ne_u32 s[62:63], s60, v129
    s_or_b64 vcc, vcc, s[62:63]
    s_cmp_ge_u32 s61, 131072
    s_cbranch_scc1 POLLX_FFA
    s_cmp_eq_u64 vcc, 0
    s_cbranch_scc1 POLLX_FFA
    s_sleep 4
    s_branch POLL_FFA
POLLX_FFA:
    s_add_u32 s48, s14, 0xa0000
    s_addc_u32 s49, s15, 0
    s_mov_b32 s50, 0x70000
    s_mov_b32 s51, 0x00020000
    v_mul_u32_u24 v136, 0x7000, v144
    v_lshl_add_u32 v136, v145, 5, v136
    s_and_b32 s40, s16, 1
    s_lshl_b32 s40, s40, 5
    s_add_u32 s40, s40, s18
    s_lshl_b32 s40, s40, 2
    s_add_u32 s40, s40, s47
    v_mov_b64 v[48:49], 0
    v_mov_b64 v[50:51], 0
    v_mov_b64 v[52:53], 0
    v_mov_b64 v[54:55], 0
    buffer_load_dwordx4 v[64:67], v136, s[48:51], s40 offen sc1
    buffer_load_dwordx4 v[68:71], v136, s[48:51], s40 offen offset:16 sc1
    s_add_u32 s40, s40, 4096
    buffer_load_dwordx4 v[72:75], v136, s[48:51], s40 offen sc1
    buffer_load_dwordx4 v[76:79], v136, s[48:51], s40 offen offset:16 sc1
    s_add_u32 s40, s40, 4096
    buffer_load_dwordx4 v[80:83], v136, s[48:51], s40 offen sc1
    buffer_load_dwordx4 v[84:87], v136, s[48:51], s40 offen offset:16 sc1
    s_add_u32 s40, s40, 4096
    buffer_load_dwordx4 v[88:91], v136, s[48:51], s40 offen sc1
    buffer_load_dwordx4 v[92:95], v136, s[48:51], s40 offen offset:16 sc1
    s_add_u32 s40, s40, 4096
    s_waitcnt vmcnt(0)
    v_pk_add_f32 v[48:49], v[48:49], v[64:65]
    v_pk_add_f32 v[50:51], v[50:51], v[66:67]
    v_pk_add_f32 v[52:53], v[52:53], v[68:69]
    v_pk_add_f32 v[54:55], v[54:55], v[70:71]
    v_pk_add_f32 v[48:49], v[48:49], v[72:73]
    v_pk_add_f32 v[50:51], v[50:51], v[74:75]
    v_pk_add_f32 v[52:53], v[52:53], v[76:77]
    v_pk_add_f32 v[54:55], v[54:55], v[78:79]
    v_pk_add_f32 v[48:49], v[48:49], v[80:81]
    v_pk_add_f32 v[50:51], v[50:51], v[82:83]
    v_pk_add_f32 v[52:53], v[52:53], v[84:85]
    v_pk_add_f32 v[54:55], v[54:55], v[86:87]
    v_pk_add_f32 v[48:49], v[48:49], v[88:89]
    v_pk_add_f32 v[50:51], v[50:51], v[90:91]
    v_pk_add_f32 v[52:53], v[52:53], v[92:93]
    v_pk_add_f32 v[54:55], v[54:55], v[94:95]
    buffer_load_dwordx4 v[64:67], v136, s[48:51], s40 offen sc1
    buffer_load_dwordx4 v[68:71], v136, s[48:51], s40 offen offset:16 sc1
    s_add_u32 s40, s40, 4096
    buffer_load_dwordx4 v[72:75], v136, s[48:51], s40 offen sc1
    buffer_load_dwordx4 v[76:79], v136, s[48:51], s40 offen offset:16 sc1
    s_add_u32 s40, s40, 4096
    buffer_load_dwordx4 v[80:83], v136, s[48:51], s40 offen sc1
    buffer_load_dwordx4 v[84:87], v136, s[48:51], s40 offen offset:16 sc1
    s_add_u32 s40, s40, 4096
    s_waitcnt vmcnt(0)
    v_pk_add_f32 v[48:49], v[48:49], v[64:65]
    v_pk_add_f32 v[50:51], v[50:51], v[66:67]
    v_pk_add_f32 v[52:53], v[52:53], v[68:69]
    v_pk_add_f32 v[54:55], v[54:55], v[70:71]
    v_pk_add_f32 v[48:49], v[48:49], v[72:73]
    v_pk_add_f32 v[50:51], v[50:51], v[74:75]
    v_pk_add_f32 v[52:53], v[52:53], v[76:77]
    v_pk_add_f32 v[54:55], v[54:55], v[78:79]
    v_pk_add_f32 v[48:49], v[48:49], v[80:81]
    v_pk_add_f32 v[50:51], v[50:51], v[82:83]
    v_pk_add_f32 v[52:53], v[52:53], v[84:85]
    v_pk_add_f32 v[54:55], v[54:55], v[86:87]
    s_nop 1
    v_add_f32_dpp v48, v48, v48 row_ror:4 row_mask:0xf bank_mask:0xf
    v_add_f32_dpp v49, v49, v49 row_ror:4 row_mask:0xf bank_mask:0xf
    v_add_f32_dpp v50, v50, v50 row_ror:4 row_mask:0xf bank_mask:0xf
    v_add_f32_dpp v51, v51, v51 row_ror:4 row_mask:0xf bank_mask:0xf
    v_add_f32_dpp v52, v52, v52 row_ror:4 row_mask:0xf bank_mask:0xf
    v_add_f32_dpp v53, v53, v53 row_ror:4 row_mask:0xf bank_mask:0xf
    v_add_f32_dpp v54, v54, v54 row_ror:4 row_mask:0xf bank_mask:0xf
    v_add_f32_dpp v55, v55, v55 row_ror:4 row_mask:0xf bank_mask:0xf
    s_nop 1
    v_add_f32_dpp v48, v48, v48 row_ror:8 row_mask:0xf bank_mask:0xf
    v_add_f32_dpp v49, v49, v49 row_ror:8 row_mask:0xf bank_mask:0xf
    v_add_f32_dpp v50, v50, v50 row_ror:8 row_mask:0xf bank_mask:0xf
    v_add_f32_dpp v51, v51, v51 row_ror:8 row_mask:0xf bank_mask:0xf
    v_add_f32_dpp v52, v52, v52 row_ror:8 row_mask:0xf bank_mask:0xf
    v_add_f32_dpp v53, v53, v53 row_ror:8 row_mask:0xf bank_mask:0xf
    v_add_f32_dpp v54, v54, v54 row_ror:8 row_mask:0xf bank_mask:0xf
    v_add_f32_dpp v55, v55, v55 row_ror:8 row_mask:0xf bank_mask:0xf
    v_mov_b32 v56, v48
    v_mov_b32 v57, v49
    v_mov_b32 v58, v50
    v_mov_b32 v59, v51
    v_mov_b32 v60, v52
    v_mov_b32 v61, v53
    v_mov_b32 v62, v54
    v_mov_b32 v63, v55
    s_nop 1
    v_permlane16_swap_b32 v48, v56
    v_permlane16_swap_b32 v49, v57
    v_permlane16_swap_b32 v50, v58
    v_permlane16_swap_b32 v51, v59
    v_permlane16_swap_b32 v52, v60
    v_permlane16_swap_b32 v53, v61
    v_permlane16_swap_b32 v54, v62
    v_permlane16_swap_b32 v55, v63
    s_nop 1
    v_add_f32 v48, v48, v56
    v_add_f32 v49, v49, v57
    v_add_f32 v50, v50, v58
    v_add_f32 v51, v51, v59
    v_add_f32 v52, v52, v60
    v_add_f32 v53, v53, v61
    v_add_f32 v54, v54, v62
    v_add_f32 v55, v55, v63
    v_mov_b32 v56, v48
    v_mov_b32 v57, v49
    v_mov_b32 v58, v50
    v_mov_b32 v59, v51
    v_mov_b32 v60, v52
    v_mov_b32 v61, v53
    v_mov_b32 v62, v54
    v_mov_b32 v63, v55
    s_nop 1
    v_permlane32_swap_b32 v48, v56
    v_permlane32_swap_b32 v49, v57
    v_permlane32_swap_b32 v50, v58
    v_permlane32_swap_b32 v51, v59
    v_permlane32_swap_b32 v52, v60
    v_permlane32_swap_b32 v53, v61
    v_permlane32_swap_b32 v54, v62
    v_permlane32_swap_b32 v55, v63
    s_nop 1
    v_add_f32 v48, v48, v56
    v_add_f32 v49, v49, v57
    v_add_f32 v50, v50, v58
    v_add_f32 v51, v51, v59
    v_add_f32 v52, v52, v60
    v_add_f32 v53, v53, v61
    v_add_f32 v54, v54, v62
    v_add_f32 v55, v55, v63
    s_and_b32 s40, s58, 0xffff0000
    s_ashr_i32 s41, s40, 31
    s_not_b32 s41, s41
    s_or_b32 s41, s41, 0x80000000
    s_xor_b32 s40, s40, s41
    s_and_b32 s40, s40, 0xffff0000
    v_mov_b32 v136, s40
    v_mul_f32 v136, 0xbfb8aa3b, v136
    v_exp_f32 v136, v136
    s_nop 0
    v_add_f32 v136, 1.0, v136
    v_rcp_f32 v136, v136
    s_nop 0
    v_cvt_pk_bf16_f32 v136, v136, v136
    v_lshlrev_b32 v136, 16, v136
    v_cvt_pk_bf16_f32 v56, v48, v49
    v_cvt_pk_bf16_f32 v57, v50, v51
    v_cvt_pk_bf16_f32 v58, v52, v53
    v_cvt_pk_bf16_f32 v59, v54, v55
    v_lshlrev_b32 v48, 16, v56
    v_and_b32 v49, s42, v56
    v_lshlrev_b32 v50, 16, v57
    v_and_b32 v51, s42, v57
    v_lshlrev_b32 v52, 16, v58
    v_and_b32 v53, s42, v58
    v_lshlrev_b32 v54, 16, v59
    v_and_b32 v55, s42, v59
    v_mul_f32 v48, v48, v136
    v_mul_f32 v49, v49, v136
    v_mul_f32 v50, v50, v136
    v_mul_f32 v51, v51, v136
    v_mul_f32 v52, v52, v136
    v_mul_f32 v53, v53, v136
    v_mul_f32 v54, v54, v136
    v_mul_f32 v55, v55, v136
    v_cvt_pk_bf16_f32 v56, v48, v49
    v_cvt_pk_bf16_f32 v57, v50, v51
    v_cvt_pk_bf16_f32 v58, v52, v53
    v_cvt_pk_bf16_f32 v59, v54, v55
    v_lshlrev_b32 v48, 16, v56
    v_and_b32 v49, s42, v56
    v_lshlrev_b32 v50, 16, v57
    v_and_b32 v51, s42, v57
    v_lshlrev_b32 v52, 16, v58
    v_and_b32 v53, s42, v58
    v_lshlrev_b32 v54, 16, v59
    v_and_b32 v55, s42, v59
    v_add_u32 v136, 0, v144
    v_cmp_eq_u32 vcc, s59, v136
    v_add_f32 v56, v48, v96
    v_add_f32 v57, v49, v97
    v_add_f32 v58, v50, v98
    v_add_f32 v59, v51, v99
    v_add_f32 v60, v52, v100
    v_add_f32 v61, v53, v101
    v_add_f32 v62, v54, v102
    v_add_f32 v63, v55, v103
    v_cvt_pk_bf16_f32 v56, v56, v57
    v_cvt_pk_bf16_f32 v57, v58, v59
    v_cvt_pk_bf16_f32 v58, v60, v61
    v_cvt_pk_bf16_f32 v59, v62, v63
    v_and_b32 v63, s42, v59
    v_lshlrev_b32 v62, 16, v59
    v_and_b32 v61, s42, v58
    v_lshlrev_b32 v60, 16, v58
    v_and_b32 v59, s42, v57
    v_lshlrev_b32 v58, 16, v57
    v_and_b32 v57, s42, v56
    v_lshlrev_b32 v56, 16, v56
    v_cndmask_b32 v96, v96, v56, vcc
    v_cndmask_b32 v97, v97, v57, vcc
    v_cndmask_b32 v98, v98, v58, vcc
    v_cndmask_b32 v99, v99, v59, vcc
    v_cndmask_b32 v100, v100, v60, vcc
    v_cndmask_b32 v101, v101, v61, vcc
    v_cndmask_b32 v102, v102, v62, vcc
    v_cndmask_b32 v103, v103, v63, vcc
    v_add_u32 v136, 16, v144
    v_cmp_eq_u32 vcc, s59, v136
    v_add_f32 v56, v48, v104
    v_add_f32 v57, v49, v105
    v_add_f32 v58, v50, v106
    v_add_f32 v59, v51, v107
    v_add_f32 v60, v52, v108
    v_add_f32 v61, v53, v109
    v_add_f32 v62, v54, v110
    v_add_f32 v63, v55, v111
    v_cvt_pk_bf16_f32 v56, v56, v57
    v_cvt_pk_bf16_f32 v57, v58, v59
    v_cvt_pk_bf16_f32 v58, v60, v61
    v_cvt_pk_bf16_f32 v59, v62, v63
    v_and_b32 v63, s42, v59
    v_lshlrev_b32 v62, 16, v59
    v_and_b32 v61, s42, v58
    v_lshlrev_b32 v60, 16, v58
    v_and_b32 v59, s42, v57
    v_lshlrev_b32 v58, 16, v57
    v_and_b32 v57, s42, v56
    v_lshlrev_b32 v56, 16, v56
    v_cndmask_b32 v104, v104, v56, vcc
    v_cndmask_b32 v105, v105, v57, vcc
    v_cndmask_b32 v106, v106, v58, vcc
    v_cndmask_b32 v107, v107, v59, vcc
    v_cndmask_b32 v108, v108, v60, vcc
    v_cndmask_b32 v109, v109, v61, vcc
    v_cndmask_b32 v110, v110, v62, vcc
    v_cndmask_b32 v111, v111, v63, vcc
    s_branch PUN_A
.section .rodata,"a"
.p2align 6
.amdhsa_kernel recurrent_scan__grouped_kv_mqa__moe_arch_mod__prompt_kernel
  .amdhsa_next_free_vgpr 168
  .amdhsa_next_free_sgpr 80
  .amdhsa_accum_offset 168
  .amdhsa_group_segment_fixed_size 0
  .amdhsa_kernarg_size 104
  .amdhsa_user_sgpr_count 2
  .amdhsa_user_sgpr_kernarg_segment_ptr 1
  .amdhsa_system_sgpr_workgroup_id_x 1
.end_amdhsa_kernel
```
